```python
import torch

def _softmax(x, axis=-1):
    return torch.softmax(x, dim=axis)
def _gelu(x):
    return torch.nn.functional.gelu(x, approximate="tanh")
def _silu(x):
    return torch.nn.functional.silu(x)
def _sigmoid(x):
    return torch.sigmoid(x)
def _layernorm(x, axis=-1, eps=1e-5):
    m = x.mean(dim=axis, keepdim=True)
    v = x.var(dim=axis, keepdim=True, unbiased=False)
    return (x - m) / torch.sqrt(v + eps)
def _scatter_add(tgt, idx, src, axis=0):
    return tgt.clone().index_add_(axis, idx, src)
def _segment_sum(src, seg, n):
    out = torch.zeros((n,) + src.shape[1:], dtype=src.dtype)
    return out.index_add_(0, seg, src)
def _pad(x, pw):
    flat = tuple(v for pair in reversed(pw) for v in pair)
    return torch.nn.functional.pad(x, flat)

kernel_name = 'gated_mix__ssm_conv_s4d__glu_gated_geglu__prompt'

def setup_inputs():

    _w = (lambda a: (lambda t: t.to(torch.bfloat16) if t.is_floating_point() else t)(torch.as_tensor(a)))
    def _A_setup():
        Bsz, L, D, N = 1, 2048, 512, 128
        return {
            "u": _w((lambda *s: torch.randn(*s, dtype=torch.bfloat16) * 0.05)(Bsz, L, D)),
            "log_A_real": _w((lambda *s: torch.randn(*s, dtype=torch.bfloat16) * 6.4)(D, N) * 0.5),
            "A_imag": _w((lambda *s: torch.randn(*s, dtype=torch.bfloat16) * 0.05)(D, N) * 3.14),
            "C_real": _w((lambda *s: torch.randn(*s, dtype=torch.bfloat16) * 0.05)(D, N) / N ** 0.5),
            "C_imag": _w((lambda *s: torch.randn(*s, dtype=torch.bfloat16) * 0.05)(D, N) / N ** 0.5),
            "log_dt": _w((lambda *s: torch.randn(*s, dtype=torch.bfloat16) * 0.05)(D) * 0.5 - 4.0),
            "D_skip": _w((lambda *s: torch.randn(*s, dtype=torch.bfloat16) * 0.05)(D)),
        }
    _A_in = _A_setup()

    def _B_setup():
        B, S, Dm, Df = 1, 2048, 512, 1376
        return {
            "x": _w((lambda *s: torch.randn(*s, dtype=torch.bfloat16) * 0.05)(B, S, Dm)),
            "w_gate": _w((lambda *s: torch.randn(*s, dtype=torch.bfloat16) * 1.6)(Dm, Df) * (Dm ** -0.5)),
            "w_up": _w((lambda *s: torch.randn(*s, dtype=torch.bfloat16) * 1.6)(Dm, Df) * (Dm ** -0.5)),
            "w_down": _w((lambda *s: torch.randn(*s, dtype=torch.bfloat16) * 1.6)(Df, Dm) * (Df ** -0.5)),
        }
    _B_in = _B_setup()

    return {
        "A_u": _A_in["u"],
        "A_log_A_real": _A_in["log_A_real"],
        "A_A_imag": _A_in["A_imag"],
        "A_C_real": _A_in["C_real"],
        "A_C_imag": _A_in["C_imag"],
        "A_log_dt": _A_in["log_dt"],
        "A_D_skip": _A_in["D_skip"],
        "B_x": _B_in["x"],
        "B_w_gate": _B_in["w_gate"],
        "B_w_up": _B_in["w_up"],
        "B_w_down": _B_in["w_down"],
        "gate_w": _w((lambda *s: torch.randn(*s, dtype=torch.bfloat16) * 0.05)(512) * 16.0),
    }

def reference(A_u, A_log_A_real, A_A_imag, A_C_real, A_C_imag, A_log_dt, A_D_skip, B_x, B_w_gate, B_w_up, B_w_down, gate_w):
    def _A_ref(u, log_A_real, A_imag, C_real, C_imag, log_dt, D_skip):
        L = u.shape[1]
        dt = torch.exp(log_dt)
        A = -torch.exp(log_A_real) + 1j * A_imag
        C = (C_real + 1j * C_imag) * dt[:, None]
        pos = (lambda x, dt: x.to(dt))(torch.arange(L), log_dt.dtype)
        P = torch.exp((A * dt[:, None])[:, :, None] * pos[None, None, :])
        K = 2.0 * torch.einsum("dn,dnl->dl", C, P).real
        L2 = 2 * L
        u_t = (lambda x, *d: x.permute(*d))(u, 0, 2, 1)
        Kf = (lambda x, *a, **k: torch.fft.rfft(x.float(), *a, **k))(K, L2)
        Uf = (lambda x, *a, **k: torch.fft.rfft(x.float(), *a, **k))(u_t, L2)
        y = (lambda x, *a, **k: torch.fft.irfft(x, *a, **k).to(torch.bfloat16))(Uf * Kf[None, :, :], L2)[:, :, :L]
        y = (lambda x, *d: x.permute(*d))(y, 0, 2, 1)
        return y + u * D_skip[None, None, :]

    def _B_ref(x, w_gate, w_up, w_down):
        g = torch.einsum("bsd,df->bsf", x, w_gate)
        u = torch.einsum("bsd,df->bsf", x, w_up)
        h = _gelu(g) * u
        return torch.einsum("bsf,fd->bsd", h, w_down)

    x = A_u
    g = _sigmoid((x * gate_w).sum(-1, keepdims=True))
    a = _A_ref(x, A_log_A_real, A_A_imag, A_C_real, A_C_imag, A_log_dt, A_D_skip)
    b = _B_ref(x, B_w_gate, B_w_up, B_w_down)
    return g * a + (1 - g) * b
```

```asm
; @launch grid=(256,1,1) block=(512,1,1) lds=163840
.amdgcn_target "amdgcn-amd-amdhsa--gfx950"
.text
.globl gated_mix__ssm_conv_s4d__glu_gated_geglu__prompt_kernel
.p2align 8
.type gated_mix__ssm_conv_s4d__glu_gated_geglu__prompt_kernel,@function
gated_mix__ssm_conv_s4d__glu_gated_geglu__prompt_kernel:
ka_start:
    s_cmp_ge_u32 s2, 256
    s_cbranch_scc1 A_exit
    s_load_dwordx16 s[32:47], s[0:1], 0
    s_load_dwordx8 s[48:55], s[0:1], 64
    s_load_dwordx4 s[56:59], s[0:1], 96
    s_load_dwordx2 s[60:61], s[0:1], 112
    s_getpc_b64 s[26:27]
pf_here:
    s_bfe_u32 s28, s2, 0x30003
    s_lshl_b32 s28, s28, 13
    v_lshl_add_u32 v226, v0, 4, s28
    s_sub_u32 s26, s26, pf_here-ka_start
    s_subb_u32 s27, s27, 0
    v_min_u32 v226, ka_end-ka_start-16, v226
    global_load_dwordx4 v[228:231], v226, s[26:27]
    v_lshrrev_b32 v2, 6, v0
    v_and_b32 v1, 63, v0
    v_readfirstlane_b32 s3, v2
    s_and_b32 s62, s2, 7
    s_lshr_b32 s63, s2, 3
    s_lshr_b32 s65, s62, 1
    s_mul_i32 s66, s65, 28
    s_add_u32 s66, s66, s63
    s_lshl_b32 s65, s65, 1
    s_and_b32 s64, s63, 1
    s_add_u32 s64, s64, s65
    s_bfe_u32 s65, s63, 0x10001
    s_add_u32 s65, s65, 14
    s_lshl_b32 s65, s65, 3
    s_add_u32 s65, s65, s64
    s_cmp_ge_u32 s63, 28
    s_cselect_b32 s66, s65, s66
    s_lshr_b32 s65, s66, 3
    s_and_b32 s64, s66, 7
    s_and_b32 s66, s62, 1
    s_lshl_b32 s66, s66, 3
    s_add_u32 s64, s64, s66
    s_lshl_b32 s66, s64, 4
    s_add_u32 s66, s66, s65
    s_and_b32 s77, s3, 3
    s_add_u32 s76, s65, s64
    s_and_b32 s76, s76, 3
    s_lshl_b32 s76, s76, 1
    s_mov_b32 s101, 0x40000
    v_lshrrev_b32 v2, 3, v1
    v_and_b32 v3, 7, v1
    v_lshrrev_b32 v4, 4, v1
    s_lshl_b32 s68, s64, 7
    s_lshl_b32 s69, s77, 5
    s_add_u32 s68, s68, s69
    v_add_u32 v2, s68, v2
    v_lshlrev_b32 v2, 10, v2
    v_xor_b32 v5, v4, v3
    v_lshl_add_u32 v236, v5, 4, v2
    v_xor_b32 v237, 64, v236
    v_add_u32 v237, 8192, v237
    v_add_u32 v238, 16384, v236
    v_add_u32 v239, 16384, v237
    s_lshl_b32 s72, s77, 12
    s_cmp_lt_u32 s3, 4
    s_cbranch_scc1 A_front
    s_lshl_b32 s20, s66, 9
    s_lshl_b32 s21, s77, 7
    s_add_u32 s20, s20, s21
    s_lshr_b32 s21, s20, 8
    s_lshl_b32 s21, s21, 1
    v_lshl_add_u32 v9, v1, 1, s20
    v_mov_b32 v8, s21
    s_waitcnt lgkmcnt(0)
    s_lshl_b32 s20, s2, 3
    s_add_u32 s20, s20, s3
    s_cmp_eq_u32 s20, 1924
    s_cbranch_scc1 dotag1
notag1:
    global_load_ushort v10, v9, s[34:35]
    global_load_ushort v11, v9, s[36:37]
    global_load_ushort v12, v9, s[38:39]
    global_load_ushort v13, v9, s[40:41]
    global_load_ushort v14, v8, s[42:43]
    s_barrier
    s_branch A_helper
A_front:
    s_waitcnt lgkmcnt(0)
    s_mov_b32 s4, s32
    s_mov_b32 s5, s33
    s_mov_b32 s6, 0x200000
    s_mov_b32 s7, 0x20000
    s_add_u32 s74, s76, 0
    s_and_b32 s74, s74, 7
    s_mul_i32 s75, s74, 176128
    s_lshl_b32 s74, s74, 7
    s_add_u32 m0, s72, 34816
    s_nop 0
    buffer_load_dwordx4 v236, s[4:7], s74 offen lds
    s_add_u32 m0, s72, 35840
    s_nop 0
    buffer_load_dwordx4 v237, s[4:7], s74 offen lds
    s_add_u32 m0, s72, 36864
    s_nop 0
    buffer_load_dwordx4 v238, s[4:7], s74 offen lds
    s_add_u32 m0, s72, 37888
    s_nop 0
    buffer_load_dwordx4 v239, s[4:7], s74 offen lds
    s_mul_i32 s68, s77, 192
    s_mul_i32 s69, s65, 192
    s_mov_b32 s70, 43691
    v_add_u32 v2, s68, v1
    v_add_u32 v5, 0, v2
    v_mul_u32_u24 v6, s70, v5
    v_lshrrev_b32 v6, 19, v6
    v_mul_u32_u24 v6, 2560, v6
    v_lshl_add_u32 v6, v5, 4, v6
    v_add_u32 v240, s69, v6
    v_add_u32 v5, 64, v2
    v_mul_u32_u24 v6, s70, v5
    v_lshrrev_b32 v6, 19, v6
    v_mul_u32_u24 v6, 2560, v6
    v_lshl_add_u32 v6, v5, 4, v6
    v_add_u32 v241, s69, v6
    v_add_u32 v5, 128, v2
    v_mul_u32_u24 v6, s70, v5
    v_lshrrev_b32 v6, 19, v6
    v_mul_u32_u24 v6, 2560, v6
    v_lshl_add_u32 v6, v5, 4, v6
    v_add_u32 v242, s69, v6
    s_cmp_ge_u32 s65, 14
    s_cbranch_scc1 mask2
nomask2:
    s_mul_i32 s73, s77, 3072
    s_add_u32 s73, s73, 16384
    s_barrier
    s_mov_b32 s8, s48
    s_mov_b32 s9, s49
    s_mov_b32 s10, 0x158000
    s_mov_b32 s11, 0x20000
    s_mov_b32 s12, s50
    s_mov_b32 s13, s51
    s_mov_b32 s14, 0x158000
    s_mov_b32 s15, 0x20000
    s_add_u32 m0, s73, 34816
    s_nop 0
    buffer_load_dwordx4 v240, s[8:11], s75 offen lds
    s_add_u32 m0, s73, 47136
    s_nop 0
    buffer_load_dwordx4 v240, s[12:15], s75 offen lds
    s_add_u32 m0, s73, 35840
    s_nop 0
    buffer_load_dwordx4 v241, s[8:11], s75 offen lds
    s_add_u32 m0, s73, 48160
    s_nop 0
    buffer_load_dwordx4 v241, s[12:15], s75 offen lds
    s_add_u32 m0, s73, 36864
    s_nop 0
    buffer_load_dwordx4 v242, s[8:11], s75 offen lds
    s_add_u32 m0, s73, 49184
    s_nop 0
    buffer_load_dwordx4 v242, s[12:15], s75 offen lds
    s_and_b32 s67, s3, 1
    s_lshr_b32 s68, s3, 1
A_front2:
    s_lshl_b32 s22, s66, 1
    s_add_u32 s22, s22, s68
    s_lshl_b32 s22, s22, 1
    v_mov_b32 v220, s22
    global_load_ushort v220, v220, s[44:45]
    s_lshl_b32 s25, s64, 1
    s_add_u32 s25, s25, s67
    s_lshl_b32 s25, s25, 4
    s_add_u32 s25, s25, s65
    s_lshl_b32 s25, s25, 1
    s_add_u32 s25, s25, s68
    s_lshl_b32 s25, s25, 7
    s_add_u32 s25, s25, 65664
    s_cmp_eq_u32 s65, 15
    s_cbranch_scc1 A_idle
    s_add_u32 s20, s65, s68
    s_cmp_eq_u32 s20, 15
    s_cbranch_scc1 A_gate
    v_and_b32 v2, 31, v1
    v_lshrrev_b32 v3, 5, v1
    v_bfe_u32 v4, v1, 1, 3
    s_lshl_b32 s69, s67, 13
    s_add_u32 s69, s69, 34816
    v_lshlrev_b32 v5, 7, v2
    v_add_u32 v5, s69, v5
    v_or_b32 v6, 0, v3
    v_xor_b32 v6, v6, v4
    v_lshl_add_u32 v152, v6, 4, v5
    v_add_u32 v156, 41216, v152
    v_add_u32 v160, 82432, v152
    v_or_b32 v6, 2, v3
    v_xor_b32 v6, v6, v4
    v_lshl_add_u32 v153, v6, 4, v5
    v_add_u32 v157, 41216, v153
    v_add_u32 v161, 82432, v153
    v_or_b32 v6, 4, v3
    v_xor_b32 v6, v6, v4
    v_lshl_add_u32 v154, v6, 4, v5
    v_add_u32 v158, 41216, v154
    v_add_u32 v162, 82432, v154
    v_or_b32 v6, 6, v3
    v_xor_b32 v6, v6, v4
    v_lshl_add_u32 v155, v6, 4, v5
    v_add_u32 v159, 41216, v155
    v_add_u32 v163, 82432, v155
    v_bfe_u32 v6, v1, 4, 1
    v_mul_u32_u24 v6, 12320, v6
    v_lshlrev_b32 v7, 3, v3
    v_bfe_u32 v8, v1, 2, 2
    v_add_u32 v7, v7, v8
    v_mul_u32_u24 v7, 192, v7
    v_add_u32 v6, v6, v7
    v_and_b32 v7, 3, v1
    v_lshl_add_u32 v6, v7, 3, v6
    s_mul_i32 s69, s68, 96
    s_add_u32 s69, s69, 51200
    v_add_u32 v164, s69, v6
    v_add_u32 v165, 41216, v164
    v_add_u32 v166, 82432, v164
    v_mov_b32 v204, 0xc0135761
    v_mov_b32 v205, 0xc0135761
    v_mov_b32 v206, 0xbdd2d3e8
    v_mov_b32 v207, 0xbdd2d3e8
    v_mov_b32 v208, 1.0
    v_mov_b32 v209, 1.0
    s_add_u32 s74, s76, 1
    s_and_b32 s74, s74, 7
    s_mul_i32 s75, s74, 176128
    s_lshl_b32 s74, s74, 7
    s_add_u32 m0, s72, 76032
    s_nop 0
    buffer_load_dwordx4 v236, s[4:7], s74 offen lds
    s_add_u32 m0, s72, 77056
    s_nop 0
    buffer_load_dwordx4 v237, s[4:7], s74 offen lds
    s_add_u32 m0, s72, 78080
    s_nop 0
    buffer_load_dwordx4 v238, s[4:7], s74 offen lds
    s_add_u32 m0, s72, 79104
    s_nop 0
    buffer_load_dwordx4 v239, s[4:7], s74 offen lds
    s_add_u32 m0, s73, 76032
    s_nop 0
    buffer_load_dwordx4 v240, s[8:11], s75 offen lds
    s_add_u32 m0, s73, 88352
    s_nop 0
    buffer_load_dwordx4 v240, s[12:15], s75 offen lds
    s_add_u32 m0, s73, 77056
    s_nop 0
    buffer_load_dwordx4 v241, s[8:11], s75 offen lds
    s_add_u32 m0, s73, 89376
    s_nop 0
    buffer_load_dwordx4 v241, s[12:15], s75 offen lds
    s_add_u32 m0, s73, 78080
    s_nop 0
    buffer_load_dwordx4 v242, s[8:11], s75 offen lds
    s_add_u32 m0, s73, 90400
    s_nop 0
    buffer_load_dwordx4 v242, s[12:15], s75 offen lds
    s_mov_b32 s16, s60
    s_mov_b32 s17, s61
    s_mov_b32 s18, 0x560000
    s_mov_b32 s19, 0x20000
    s_lshl_b32 s70, s64, 2
    s_lshl_b32 s71, s67, 1
    s_add_u32 s70, s70, s71
    s_mul_i32 s70, s70, 86
    s_mul_i32 s71, s65, 6
    s_mul_i32 s72, s68, 3
    s_add_u32 s71, s71, s72
    s_add_u32 s70, s70, s71
    s_lshl_b32 s70, s70, 10
    v_lshlrev_b32 v9, 4, v1
    s_waitcnt vmcnt(10)
    s_barrier
    ds_read_b128 v[124:127], v152 offset:0
    ds_read_b64_tr_b16 v[112:113], v164 offset:0
    ds_read_b64_tr_b16 v[114:115], v164 offset:768
    ds_read_b128 v[128:131], v152 offset:4096
    ds_read_b64_tr_b16 v[116:117], v164 offset:32
    ds_read_b64_tr_b16 v[118:119], v164 offset:800
    ds_read_b64_tr_b16 v[120:121], v164 offset:64
    ds_read_b64_tr_b16 v[122:123], v164 offset:832
    s_waitcnt lgkmcnt(0)
    v_mfma_f32_32x32x16_bf16 v[16:31], v[112:115], v[124:127], 0
    ds_read_b128 v[144:147], v153 offset:0
    ds_read_b64_tr_b16 v[132:133], v164 offset:3072
    v_mfma_f32_32x32x16_bf16 v[32:47], v[112:115], v[128:131], 0
    ds_read_b64_tr_b16 v[134:135], v164 offset:3840
    ds_read_b128 v[148:151], v153 offset:4096
    v_mfma_f32_32x32x16_bf16 v[48:63], v[116:119], v[124:127], 0
    ds_read_b64_tr_b16 v[136:137], v164 offset:3104
    ds_read_b64_tr_b16 v[138:139], v164 offset:3872
    v_mfma_f32_32x32x16_bf16 v[64:79], v[116:119], v[128:131], 0
    ds_read_b64_tr_b16 v[140:141], v164 offset:3136
    v_mfma_f32_32x32x16_bf16 v[80:95], v[120:123], v[124:127], 0
    ds_read_b64_tr_b16 v[142:143], v164 offset:3904
    v_mfma_f32_32x32x16_bf16 v[96:111], v[120:123], v[128:131], 0
    s_waitcnt lgkmcnt(0)
    v_mfma_f32_32x32x16_bf16 v[16:31], v[132:135], v[144:147], v[16:31]
    ds_read_b128 v[124:127], v154 offset:0
    ds_read_b64_tr_b16 v[112:113], v164 offset:6144
    v_mfma_f32_32x32x16_bf16 v[32:47], v[132:135], v[148:151], v[32:47]
    ds_read_b64_tr_b16 v[114:115], v164 offset:6912
    ds_read_b128 v[128:131], v154 offset:4096
    v_mfma_f32_32x32x16_bf16 v[48:63], v[136:139], v[144:147], v[48:63]
    ds_read_b64_tr_b16 v[116:117], v164 offset:6176
    ds_read_b64_tr_b16 v[118:119], v164 offset:6944
    v_mfma_f32_32x32x16_bf16 v[64:79], v[136:139], v[148:151], v[64:79]
    ds_read_b64_tr_b16 v[120:121], v164 offset:6208
    v_mfma_f32_32x32x16_bf16 v[80:95], v[140:143], v[144:147], v[80:95]
    ds_read_b64_tr_b16 v[122:123], v164 offset:6976
    v_mfma_f32_32x32x16_bf16 v[96:111], v[140:143], v[148:151], v[96:111]
    s_waitcnt lgkmcnt(0)
    v_mfma_f32_32x32x16_bf16 v[16:31], v[112:115], v[124:127], v[16:31]
    ds_read_b128 v[144:147], v155 offset:0
    ds_read_b64_tr_b16 v[132:133], v164 offset:9216
    v_mfma_f32_32x32x16_bf16 v[32:47], v[112:115], v[128:131], v[32:47]
    ds_read_b64_tr_b16 v[134:135], v164 offset:9984
    ds_read_b128 v[148:151], v155 offset:4096
    v_mfma_f32_32x32x16_bf16 v[48:63], v[116:119], v[124:127], v[48:63]
    ds_read_b64_tr_b16 v[136:137], v164 offset:9248
    ds_read_b64_tr_b16 v[138:139], v164 offset:10016
    v_mfma_f32_32x32x16_bf16 v[64:79], v[116:119], v[128:131], v[64:79]
    ds_read_b64_tr_b16 v[140:141], v164 offset:9280
    v_mfma_f32_32x32x16_bf16 v[80:95], v[120:123], v[124:127], v[80:95]
    ds_read_b64_tr_b16 v[142:143], v164 offset:10048
    v_mfma_f32_32x32x16_bf16 v[96:111], v[120:123], v[128:131], v[96:111]
    s_waitcnt vmcnt(0) lgkmcnt(0)
    s_barrier
    v_mfma_f32_32x32x16_bf16 v[16:31], v[132:135], v[144:147], v[16:31]
    ds_read_b128 v[124:127], v156 offset:0
    ds_read_b64_tr_b16 v[112:113], v165 offset:0
    v_mfma_f32_32x32x16_bf16 v[32:47], v[132:135], v[148:151], v[32:47]
    ds_read_b64_tr_b16 v[114:115], v165 offset:768
    ds_read_b128 v[128:131], v156 offset:4096
    v_mfma_f32_32x32x16_bf16 v[48:63], v[136:139], v[144:147], v[48:63]
    ds_read_b64_tr_b16 v[116:117], v165 offset:32
    ds_read_b64_tr_b16 v[118:119], v165 offset:800
    v_mfma_f32_32x32x16_bf16 v[64:79], v[136:139], v[148:151], v[64:79]
    ds_read_b64_tr_b16 v[120:121], v165 offset:64
    v_mfma_f32_32x32x16_bf16 v[80:95], v[140:143], v[144:147], v[80:95]
    ds_read_b64_tr_b16 v[122:123], v165 offset:832
    v_mfma_f32_32x32x16_bf16 v[96:111], v[140:143], v[148:151], v[96:111]
    s_waitcnt lgkmcnt(0)
    v_mfma_f32_32x32x16_bf16 v[16:31], v[112:115], v[124:127], v[16:31]
    ds_read_b128 v[144:147], v157 offset:0
    ds_read_b64_tr_b16 v[132:133], v165 offset:3072
    v_mfma_f32_32x32x16_bf16 v[32:47], v[112:115], v[128:131], v[32:47]
    ds_read_b64_tr_b16 v[134:135], v165 offset:3840
    ds_read_b128 v[148:151], v157 offset:4096
    v_mfma_f32_32x32x16_bf16 v[48:63], v[116:119], v[124:127], v[48:63]
    ds_read_b64_tr_b16 v[136:137], v165 offset:3104
    ds_read_b64_tr_b16 v[138:139], v165 offset:3872
    v_mfma_f32_32x32x16_bf16 v[64:79], v[116:119], v[128:131], v[64:79]
    ds_read_b64_tr_b16 v[140:141], v165 offset:3136
    v_mfma_f32_32x32x16_bf16 v[80:95], v[120:123], v[124:127], v[80:95]
    ds_read_b64_tr_b16 v[142:143], v165 offset:3904
    v_mfma_f32_32x32x16_bf16 v[96:111], v[120:123], v[128:131], v[96:111]
    s_waitcnt lgkmcnt(0)
    v_mfma_f32_32x32x16_bf16 v[16:31], v[132:135], v[144:147], v[16:31]
    ds_read_b128 v[124:127], v158 offset:0
    ds_read_b64_tr_b16 v[112:113], v165 offset:6144
    v_mfma_f32_32x32x16_bf16 v[32:47], v[132:135], v[148:151], v[32:47]
    ds_read_b64_tr_b16 v[114:115], v165 offset:6912
    ds_read_b128 v[128:131], v158 offset:4096
    v_mfma_f32_32x32x16_bf16 v[48:63], v[136:139], v[144:147], v[48:63]
    ds_read_b64_tr_b16 v[116:117], v165 offset:6176
    ds_read_b64_tr_b16 v[118:119], v165 offset:6944
    v_mfma_f32_32x32x16_bf16 v[64:79], v[136:139], v[148:151], v[64:79]
    ds_read_b64_tr_b16 v[120:121], v165 offset:6208
    v_mfma_f32_32x32x16_bf16 v[80:95], v[140:143], v[144:147], v[80:95]
    ds_read_b64_tr_b16 v[122:123], v165 offset:6976
    v_mfma_f32_32x32x16_bf16 v[96:111], v[140:143], v[148:151], v[96:111]
    s_waitcnt lgkmcnt(0)
    v_mfma_f32_32x32x16_bf16 v[16:31], v[112:115], v[124:127], v[16:31]
    ds_read_b128 v[144:147], v159 offset:0
    ds_read_b64_tr_b16 v[132:133], v165 offset:9216
    v_mfma_f32_32x32x16_bf16 v[32:47], v[112:115], v[128:131], v[32:47]
    ds_read_b64_tr_b16 v[134:135], v165 offset:9984
    ds_read_b128 v[148:151], v159 offset:4096
    v_mfma_f32_32x32x16_bf16 v[48:63], v[116:119], v[124:127], v[48:63]
    ds_read_b64_tr_b16 v[136:137], v165 offset:9248
    ds_read_b64_tr_b16 v[138:139], v165 offset:10016
    v_mfma_f32_32x32x16_bf16 v[64:79], v[116:119], v[128:131], v[64:79]
    ds_read_b64_tr_b16 v[140:141], v165 offset:9280
    v_mfma_f32_32x32x16_bf16 v[80:95], v[120:123], v[124:127], v[80:95]
    ds_read_b64_tr_b16 v[142:143], v165 offset:10048
    v_mfma_f32_32x32x16_bf16 v[96:111], v[120:123], v[128:131], v[96:111]
    s_waitcnt lgkmcnt(0)
    s_barrier
    v_mfma_f32_32x32x16_bf16 v[16:31], v[132:135], v[144:147], v[16:31]
    ds_read_b128 v[124:127], v160 offset:0
    ds_read_b64_tr_b16 v[112:113], v166 offset:0
    v_mfma_f32_32x32x16_bf16 v[32:47], v[132:135], v[148:151], v[32:47]
    ds_read_b64_tr_b16 v[114:115], v166 offset:768
    ds_read_b128 v[128:131], v160 offset:4096
    v_mfma_f32_32x32x16_bf16 v[48:63], v[136:139], v[144:147], v[48:63]
    ds_read_b64_tr_b16 v[116:117], v166 offset:32
    ds_read_b64_tr_b16 v[118:119], v166 offset:800
    v_mfma_f32_32x32x16_bf16 v[64:79], v[136:139], v[148:151], v[64:79]
    ds_read_b64_tr_b16 v[120:121], v166 offset:64
    v_mfma_f32_32x32x16_bf16 v[80:95], v[140:143], v[144:147], v[80:95]
    ds_read_b64_tr_b16 v[122:123], v166 offset:832
    v_mfma_f32_32x32x16_bf16 v[96:111], v[140:143], v[148:151], v[96:111]
    s_waitcnt lgkmcnt(0)
    v_mfma_f32_32x32x16_bf16 v[16:31], v[112:115], v[124:127], v[16:31]
    ds_read_b128 v[144:147], v161 offset:0
    ds_read_b64_tr_b16 v[132:133], v166 offset:3072
    v_mfma_f32_32x32x16_bf16 v[32:47], v[112:115], v[128:131], v[32:47]
    ds_read_b64_tr_b16 v[134:135], v166 offset:3840
    ds_read_b128 v[148:151], v161 offset:4096
    v_mfma_f32_32x32x16_bf16 v[48:63], v[116:119], v[124:127], v[48:63]
    ds_read_b64_tr_b16 v[136:137], v166 offset:3104
    ds_read_b64_tr_b16 v[138:139], v166 offset:3872
    v_mfma_f32_32x32x16_bf16 v[64:79], v[116:119], v[128:131], v[64:79]
    ds_read_b64_tr_b16 v[140:141], v166 offset:3136
    v_mfma_f32_32x32x16_bf16 v[80:95], v[120:123], v[124:127], v[80:95]
    ds_read_b64_tr_b16 v[142:143], v166 offset:3904
    v_mfma_f32_32x32x16_bf16 v[96:111], v[120:123], v[128:131], v[96:111]
    s_waitcnt lgkmcnt(0)
    v_mfma_f32_32x32x16_bf16 v[16:31], v[132:135], v[144:147], v[16:31]
    ds_read_b128 v[124:127], v162 offset:0
    ds_read_b64_tr_b16 v[112:113], v166 offset:6144
    v_mfma_f32_32x32x16_bf16 v[32:47], v[132:135], v[148:151], v[32:47]
    ds_read_b64_tr_b16 v[114:115], v166 offset:6912
    ds_read_b128 v[128:131], v162 offset:4096
    v_mfma_f32_32x32x16_bf16 v[48:63], v[136:139], v[144:147], v[48:63]
    ds_read_b64_tr_b16 v[116:117], v166 offset:6176
    ds_read_b64_tr_b16 v[118:119], v166 offset:6944
    v_mfma_f32_32x32x16_bf16 v[64:79], v[136:139], v[148:151], v[64:79]
    ds_read_b64_tr_b16 v[120:121], v166 offset:6208
    v_mfma_f32_32x32x16_bf16 v[80:95], v[140:143], v[144:147], v[80:95]
    ds_read_b64_tr_b16 v[122:123], v166 offset:6976
    v_mfma_f32_32x32x16_bf16 v[96:111], v[140:143], v[148:151], v[96:111]
    s_waitcnt lgkmcnt(0)
    v_mfma_f32_32x32x16_bf16 v[16:31], v[112:115], v[124:127], v[16:31]
    ds_read_b128 v[144:147], v163 offset:0
    ds_read_b64_tr_b16 v[132:133], v166 offset:9216
    v_mfma_f32_32x32x16_bf16 v[32:47], v[112:115], v[128:131], v[32:47]
    ds_read_b64_tr_b16 v[134:135], v166 offset:9984
    ds_read_b128 v[148:151], v163 offset:4096
    v_mfma_f32_32x32x16_bf16 v[48:63], v[116:119], v[124:127], v[48:63]
    ds_read_b64_tr_b16 v[136:137], v166 offset:9248
    ds_read_b64_tr_b16 v[138:139], v166 offset:10016
    v_mfma_f32_32x32x16_bf16 v[64:79], v[116:119], v[128:131], v[64:79]
    ds_read_b64_tr_b16 v[140:141], v166 offset:9280
    v_mfma_f32_32x32x16_bf16 v[80:95], v[120:123], v[124:127], v[80:95]
    ds_read_b64_tr_b16 v[142:143], v166 offset:10048
    v_mfma_f32_32x32x16_bf16 v[96:111], v[120:123], v[128:131], v[96:111]
    s_waitcnt lgkmcnt(0)
    s_barrier
    v_mfma_f32_32x32x16_bf16 v[16:31], v[132:135], v[144:147], v[16:31]
    ds_read_b128 v[124:127], v152 offset:0
    ds_read_b64_tr_b16 v[112:113], v164 offset:0
    v_mfma_f32_32x32x16_bf16 v[32:47], v[132:135], v[148:151], v[32:47]
    ds_read_b64_tr_b16 v[114:115], v164 offset:768
    ds_read_b128 v[128:131], v152 offset:4096
    v_mfma_f32_32x32x16_bf16 v[48:63], v[136:139], v[144:147], v[48:63]
    ds_read_b64_tr_b16 v[116:117], v164 offset:32
    ds_read_b64_tr_b16 v[118:119], v164 offset:800
    v_mfma_f32_32x32x16_bf16 v[64:79], v[136:139], v[148:151], v[64:79]
    ds_read_b64_tr_b16 v[120:121], v164 offset:64
    v_mfma_f32_32x32x16_bf16 v[80:95], v[140:143], v[144:147], v[80:95]
    ds_read_b64_tr_b16 v[122:123], v164 offset:832
    v_mfma_f32_32x32x16_bf16 v[96:111], v[140:143], v[148:151], v[96:111]
    s_waitcnt lgkmcnt(0)
    v_mfma_f32_32x32x16_bf16 v[16:31], v[112:115], v[124:127], v[16:31]
    ds_read_b128 v[144:147], v153 offset:0
    ds_read_b64_tr_b16 v[132:133], v164 offset:3072
    v_mfma_f32_32x32x16_bf16 v[32:47], v[112:115], v[128:131], v[32:47]
    ds_read_b64_tr_b16 v[134:135], v164 offset:3840
    ds_read_b128 v[148:151], v153 offset:4096
    v_mfma_f32_32x32x16_bf16 v[48:63], v[116:119], v[124:127], v[48:63]
    ds_read_b64_tr_b16 v[136:137], v164 offset:3104
    ds_read_b64_tr_b16 v[138:139], v164 offset:3872
    v_mfma_f32_32x32x16_bf16 v[64:79], v[116:119], v[128:131], v[64:79]
    ds_read_b64_tr_b16 v[140:141], v164 offset:3136
    v_mfma_f32_32x32x16_bf16 v[80:95], v[120:123], v[124:127], v[80:95]
    ds_read_b64_tr_b16 v[142:143], v164 offset:3904
    v_mfma_f32_32x32x16_bf16 v[96:111], v[120:123], v[128:131], v[96:111]
    s_waitcnt lgkmcnt(0)
    v_mfma_f32_32x32x16_bf16 v[16:31], v[132:135], v[144:147], v[16:31]
    ds_read_b128 v[124:127], v154 offset:0
    ds_read_b64_tr_b16 v[112:113], v164 offset:6144
    v_mfma_f32_32x32x16_bf16 v[32:47], v[132:135], v[148:151], v[32:47]
    ds_read_b64_tr_b16 v[114:115], v164 offset:6912
    ds_read_b128 v[128:131], v154 offset:4096
    v_mfma_f32_32x32x16_bf16 v[48:63], v[136:139], v[144:147], v[48:63]
    ds_read_b64_tr_b16 v[116:117], v164 offset:6176
    ds_read_b64_tr_b16 v[118:119], v164 offset:6944
    v_mfma_f32_32x32x16_bf16 v[64:79], v[136:139], v[148:151], v[64:79]
    ds_read_b64_tr_b16 v[120:121], v164 offset:6208
    v_mfma_f32_32x32x16_bf16 v[80:95], v[140:143], v[144:147], v[80:95]
    ds_read_b64_tr_b16 v[122:123], v164 offset:6976
    v_mfma_f32_32x32x16_bf16 v[96:111], v[140:143], v[148:151], v[96:111]
    s_waitcnt lgkmcnt(0)
    v_mfma_f32_32x32x16_bf16 v[16:31], v[112:115], v[124:127], v[16:31]
    ds_read_b128 v[144:147], v155 offset:0
    ds_read_b64_tr_b16 v[132:133], v164 offset:9216
    v_mfma_f32_32x32x16_bf16 v[32:47], v[112:115], v[128:131], v[32:47]
    ds_read_b64_tr_b16 v[134:135], v164 offset:9984
    ds_read_b128 v[148:151], v155 offset:4096
    v_mfma_f32_32x32x16_bf16 v[48:63], v[116:119], v[124:127], v[48:63]
    ds_read_b64_tr_b16 v[136:137], v164 offset:9248
    ds_read_b64_tr_b16 v[138:139], v164 offset:10016
    v_mfma_f32_32x32x16_bf16 v[64:79], v[116:119], v[128:131], v[64:79]
    ds_read_b64_tr_b16 v[140:141], v164 offset:9280
    v_mfma_f32_32x32x16_bf16 v[80:95], v[120:123], v[124:127], v[80:95]
    ds_read_b64_tr_b16 v[142:143], v164 offset:10048
    v_mfma_f32_32x32x16_bf16 v[96:111], v[120:123], v[128:131], v[96:111]
    s_waitcnt lgkmcnt(0)
    s_barrier
    v_mfma_f32_32x32x16_bf16 v[16:31], v[132:135], v[144:147], v[16:31]
    ds_read_b128 v[124:127], v156 offset:0
    ds_read_b64_tr_b16 v[112:113], v165 offset:0
    v_mfma_f32_32x32x16_bf16 v[32:47], v[132:135], v[148:151], v[32:47]
    ds_read_b64_tr_b16 v[114:115], v165 offset:768
    ds_read_b128 v[128:131], v156 offset:4096
    v_mfma_f32_32x32x16_bf16 v[48:63], v[136:139], v[144:147], v[48:63]
    ds_read_b64_tr_b16 v[116:117], v165 offset:32
    ds_read_b64_tr_b16 v[118:119], v165 offset:800
    v_mfma_f32_32x32x16_bf16 v[64:79], v[136:139], v[148:151], v[64:79]
    ds_read_b64_tr_b16 v[120:121], v165 offset:64
    v_mfma_f32_32x32x16_bf16 v[80:95], v[140:143], v[144:147], v[80:95]
    ds_read_b64_tr_b16 v[122:123], v165 offset:832
    v_mfma_f32_32x32x16_bf16 v[96:111], v[140:143], v[148:151], v[96:111]
    s_waitcnt lgkmcnt(0)
    v_mfma_f32_32x32x16_bf16 v[16:31], v[112:115], v[124:127], v[16:31]
    ds_read_b128 v[144:147], v157 offset:0
    ds_read_b64_tr_b16 v[132:133], v165 offset:3072
    v_mfma_f32_32x32x16_bf16 v[32:47], v[112:115], v[128:131], v[32:47]
    ds_read_b64_tr_b16 v[134:135], v165 offset:3840
    ds_read_b128 v[148:151], v157 offset:4096
    v_mfma_f32_32x32x16_bf16 v[48:63], v[116:119], v[124:127], v[48:63]
    ds_read_b64_tr_b16 v[136:137], v165 offset:3104
    ds_read_b64_tr_b16 v[138:139], v165 offset:3872
    v_mfma_f32_32x32x16_bf16 v[64:79], v[116:119], v[128:131], v[64:79]
    ds_read_b64_tr_b16 v[140:141], v165 offset:3136
    v_mfma_f32_32x32x16_bf16 v[80:95], v[120:123], v[124:127], v[80:95]
    ds_read_b64_tr_b16 v[142:143], v165 offset:3904
    v_mfma_f32_32x32x16_bf16 v[96:111], v[120:123], v[128:131], v[96:111]
    s_waitcnt lgkmcnt(0)
    v_mfma_f32_32x32x16_bf16 v[16:31], v[132:135], v[144:147], v[16:31]
    ds_read_b128 v[124:127], v158 offset:0
    ds_read_b64_tr_b16 v[112:113], v165 offset:6144
    v_mfma_f32_32x32x16_bf16 v[32:47], v[132:135], v[148:151], v[32:47]
    ds_read_b64_tr_b16 v[114:115], v165 offset:6912
    ds_read_b128 v[128:131], v158 offset:4096
    v_mfma_f32_32x32x16_bf16 v[48:63], v[136:139], v[144:147], v[48:63]
    ds_read_b64_tr_b16 v[116:117], v165 offset:6176
    ds_read_b64_tr_b16 v[118:119], v165 offset:6944
    v_mfma_f32_32x32x16_bf16 v[64:79], v[136:139], v[148:151], v[64:79]
    ds_read_b64_tr_b16 v[120:121], v165 offset:6208
    v_mfma_f32_32x32x16_bf16 v[80:95], v[140:143], v[144:147], v[80:95]
    ds_read_b64_tr_b16 v[122:123], v165 offset:6976
    v_mfma_f32_32x32x16_bf16 v[96:111], v[140:143], v[148:151], v[96:111]
    s_waitcnt lgkmcnt(0)
    v_mfma_f32_32x32x16_bf16 v[16:31], v[112:115], v[124:127], v[16:31]
    ds_read_b128 v[144:147], v159 offset:0
    ds_read_b64_tr_b16 v[132:133], v165 offset:9216
    v_mfma_f32_32x32x16_bf16 v[32:47], v[112:115], v[128:131], v[32:47]
    ds_read_b64_tr_b16 v[134:135], v165 offset:9984
    ds_read_b128 v[148:151], v159 offset:4096
    v_mfma_f32_32x32x16_bf16 v[48:63], v[116:119], v[124:127], v[48:63]
    ds_read_b64_tr_b16 v[136:137], v165 offset:9248
    ds_read_b64_tr_b16 v[138:139], v165 offset:10016
    v_mfma_f32_32x32x16_bf16 v[64:79], v[116:119], v[128:131], v[64:79]
    ds_read_b64_tr_b16 v[140:141], v165 offset:9280
    v_mfma_f32_32x32x16_bf16 v[80:95], v[120:123], v[124:127], v[80:95]
    ds_read_b64_tr_b16 v[142:143], v165 offset:10048
    v_mfma_f32_32x32x16_bf16 v[96:111], v[120:123], v[128:131], v[96:111]
    s_waitcnt lgkmcnt(0)
    s_barrier
    v_mfma_f32_32x32x16_bf16 v[16:31], v[132:135], v[144:147], v[16:31]
    ds_read_b128 v[124:127], v160 offset:0
    ds_read_b64_tr_b16 v[112:113], v166 offset:0
    v_mfma_f32_32x32x16_bf16 v[32:47], v[132:135], v[148:151], v[32:47]
    ds_read_b64_tr_b16 v[114:115], v166 offset:768
    ds_read_b128 v[128:131], v160 offset:4096
    v_mfma_f32_32x32x16_bf16 v[48:63], v[136:139], v[144:147], v[48:63]
    ds_read_b64_tr_b16 v[116:117], v166 offset:32
    ds_read_b64_tr_b16 v[118:119], v166 offset:800
    v_mfma_f32_32x32x16_bf16 v[64:79], v[136:139], v[148:151], v[64:79]
    ds_read_b64_tr_b16 v[120:121], v166 offset:64
    v_mfma_f32_32x32x16_bf16 v[80:95], v[140:143], v[144:147], v[80:95]
    ds_read_b64_tr_b16 v[122:123], v166 offset:832
    v_mfma_f32_32x32x16_bf16 v[96:111], v[140:143], v[148:151], v[96:111]
    s_waitcnt lgkmcnt(0)
    v_mfma_f32_32x32x16_bf16 v[16:31], v[112:115], v[124:127], v[16:31]
    ds_read_b128 v[144:147], v161 offset:0
    ds_read_b64_tr_b16 v[132:133], v166 offset:3072
    v_mfma_f32_32x32x16_bf16 v[32:47], v[112:115], v[128:131], v[32:47]
    ds_read_b64_tr_b16 v[134:135], v166 offset:3840
    ds_read_b128 v[148:151], v161 offset:4096
    v_mfma_f32_32x32x16_bf16 v[48:63], v[116:119], v[124:127], v[48:63]
    ds_read_b64_tr_b16 v[136:137], v166 offset:3104
    ds_read_b64_tr_b16 v[138:139], v166 offset:3872
    v_mfma_f32_32x32x16_bf16 v[64:79], v[116:119], v[128:131], v[64:79]
    ds_read_b64_tr_b16 v[140:141], v166 offset:3136
    v_mfma_f32_32x32x16_bf16 v[80:95], v[120:123], v[124:127], v[80:95]
    ds_read_b64_tr_b16 v[142:143], v166 offset:3904
    v_mfma_f32_32x32x16_bf16 v[96:111], v[120:123], v[128:131], v[96:111]
    s_waitcnt lgkmcnt(0)
    v_mfma_f32_32x32x16_bf16 v[16:31], v[132:135], v[144:147], v[16:31]
    ds_read_b128 v[124:127], v162 offset:0
    ds_read_b64_tr_b16 v[112:113], v166 offset:6144
    v_mfma_f32_32x32x16_bf16 v[32:47], v[132:135], v[148:151], v[32:47]
    ds_read_b64_tr_b16 v[114:115], v166 offset:6912
    ds_read_b128 v[128:131], v162 offset:4096
    v_mfma_f32_32x32x16_bf16 v[48:63], v[136:139], v[144:147], v[48:63]
    ds_read_b64_tr_b16 v[116:117], v166 offset:6176
    ds_read_b64_tr_b16 v[118:119], v166 offset:6944
    v_mfma_f32_32x32x16_bf16 v[64:79], v[136:139], v[148:151], v[64:79]
    ds_read_b64_tr_b16 v[120:121], v166 offset:6208
    v_mfma_f32_32x32x16_bf16 v[80:95], v[140:143], v[144:147], v[80:95]
    ds_read_b64_tr_b16 v[122:123], v166 offset:6976
    v_mfma_f32_32x32x16_bf16 v[96:111], v[140:143], v[148:151], v[96:111]
    s_waitcnt lgkmcnt(0)
    v_mfma_f32_32x32x16_bf16 v[16:31], v[112:115], v[124:127], v[16:31]
    ds_read_b128 v[144:147], v163 offset:0
    ds_read_b64_tr_b16 v[132:133], v166 offset:9216
    v_mfma_f32_32x32x16_bf16 v[32:47], v[112:115], v[128:131], v[32:47]
    ds_read_b64_tr_b16 v[134:135], v166 offset:9984
    ds_read_b128 v[148:151], v163 offset:4096
    v_mfma_f32_32x32x16_bf16 v[48:63], v[116:119], v[124:127], v[48:63]
    ds_read_b64_tr_b16 v[136:137], v166 offset:9248
    ds_read_b64_tr_b16 v[138:139], v166 offset:10016
    v_mfma_f32_32x32x16_bf16 v[64:79], v[116:119], v[128:131], v[64:79]
    ds_read_b64_tr_b16 v[140:141], v166 offset:9280
    v_mfma_f32_32x32x16_bf16 v[80:95], v[120:123], v[124:127], v[80:95]
    ds_read_b64_tr_b16 v[142:143], v166 offset:10048
    v_mfma_f32_32x32x16_bf16 v[96:111], v[120:123], v[128:131], v[96:111]
    s_waitcnt lgkmcnt(0)
    s_barrier
    v_mfma_f32_32x32x16_bf16 v[16:31], v[132:135], v[144:147], v[16:31]
    ds_read_b128 v[124:127], v152 offset:0
    ds_read_b64_tr_b16 v[112:113], v164 offset:0
    v_mfma_f32_32x32x16_bf16 v[32:47], v[132:135], v[148:151], v[32:47]
    ds_read_b64_tr_b16 v[114:115], v164 offset:768
    ds_read_b128 v[128:131], v152 offset:4096
    v_mfma_f32_32x32x16_bf16 v[48:63], v[136:139], v[144:147], v[48:63]
    ds_read_b64_tr_b16 v[116:117], v164 offset:32
    ds_read_b64_tr_b16 v[118:119], v164 offset:800
    v_mfma_f32_32x32x16_bf16 v[64:79], v[136:139], v[148:151], v[64:79]
    ds_read_b64_tr_b16 v[120:121], v164 offset:64
    v_mfma_f32_32x32x16_bf16 v[80:95], v[140:143], v[144:147], v[80:95]
    ds_read_b64_tr_b16 v[122:123], v164 offset:832
    v_mfma_f32_32x32x16_bf16 v[96:111], v[140:143], v[148:151], v[96:111]
    s_waitcnt lgkmcnt(0)
    v_mfma_f32_32x32x16_bf16 v[16:31], v[112:115], v[124:127], v[16:31]
    ds_read_b128 v[144:147], v153 offset:0
    ds_read_b64_tr_b16 v[132:133], v164 offset:3072
    v_mfma_f32_32x32x16_bf16 v[32:47], v[112:115], v[128:131], v[32:47]
    ds_read_b64_tr_b16 v[134:135], v164 offset:3840
    ds_read_b128 v[148:151], v153 offset:4096
    v_mfma_f32_32x32x16_bf16 v[48:63], v[116:119], v[124:127], v[48:63]
    ds_read_b64_tr_b16 v[136:137], v164 offset:3104
    ds_read_b64_tr_b16 v[138:139], v164 offset:3872
    v_mfma_f32_32x32x16_bf16 v[64:79], v[116:119], v[128:131], v[64:79]
    ds_read_b64_tr_b16 v[140:141], v164 offset:3136
    v_mfma_f32_32x32x16_bf16 v[80:95], v[120:123], v[124:127], v[80:95]
    ds_read_b64_tr_b16 v[142:143], v164 offset:3904
    v_mfma_f32_32x32x16_bf16 v[96:111], v[120:123], v[128:131], v[96:111]
    s_waitcnt lgkmcnt(0)
    v_mfma_f32_32x32x16_bf16 v[16:31], v[132:135], v[144:147], v[16:31]
    ds_read_b128 v[124:127], v154 offset:0
    ds_read_b64_tr_b16 v[112:113], v164 offset:6144
    v_mfma_f32_32x32x16_bf16 v[32:47], v[132:135], v[148:151], v[32:47]
    ds_read_b64_tr_b16 v[114:115], v164 offset:6912
    ds_read_b128 v[128:131], v154 offset:4096
    v_mfma_f32_32x32x16_bf16 v[48:63], v[136:139], v[144:147], v[48:63]
    ds_read_b64_tr_b16 v[116:117], v164 offset:6176
    ds_read_b64_tr_b16 v[118:119], v164 offset:6944
    v_mfma_f32_32x32x16_bf16 v[64:79], v[136:139], v[148:151], v[64:79]
    ds_read_b64_tr_b16 v[120:121], v164 offset:6208
    v_mfma_f32_32x32x16_bf16 v[80:95], v[140:143], v[144:147], v[80:95]
    ds_read_b64_tr_b16 v[122:123], v164 offset:6976
    v_mfma_f32_32x32x16_bf16 v[96:111], v[140:143], v[148:151], v[96:111]
    s_waitcnt lgkmcnt(0)
    v_mfma_f32_32x32x16_bf16 v[16:31], v[112:115], v[124:127], v[16:31]
    ds_read_b128 v[144:147], v155 offset:0
    ds_read_b64_tr_b16 v[132:133], v164 offset:9216
    v_mfma_f32_32x32x16_bf16 v[32:47], v[112:115], v[128:131], v[32:47]
    ds_read_b64_tr_b16 v[134:135], v164 offset:9984
    ds_read_b128 v[148:151], v155 offset:4096
    v_mfma_f32_32x32x16_bf16 v[48:63], v[116:119], v[124:127], v[48:63]
    ds_read_b64_tr_b16 v[136:137], v164 offset:9248
    ds_read_b64_tr_b16 v[138:139], v164 offset:10016
    v_mfma_f32_32x32x16_bf16 v[64:79], v[116:119], v[128:131], v[64:79]
    ds_read_b64_tr_b16 v[140:141], v164 offset:9280
    v_mfma_f32_32x32x16_bf16 v[80:95], v[120:123], v[124:127], v[80:95]
    ds_read_b64_tr_b16 v[142:143], v164 offset:10048
    v_mfma_f32_32x32x16_bf16 v[96:111], v[120:123], v[128:131], v[96:111]
    s_waitcnt lgkmcnt(0)
    s_mov_b64 exec, 1
    v_mov_b32 v12, 34088
    v_mov_b32 v13, 1
    ds_add_u32 v12, v13
    s_mov_b64 exec, -1
    v_mov_b32 v12, 34080
    ds_read_b64 v[10:11], v12
    v_mov_b32 v12, 34092
lw3:
    ds_read_b32 v13, v12
    s_waitcnt lgkmcnt(0)
    v_readfirstlane_b32 s22, v13
    s_cmp_ge_u32 s22, 2
    s_cbranch_scc1 lwok3
    s_sub_u32 s101, s101, 1
    s_cmp_lt_i32 s101, 0
    s_cbranch_scc1 lwok3
    s_branch lw3
lwok3:
    v_readfirstlane_b32 s30, v10
    v_readfirstlane_b32 s31, v11
    s_add_u32 s12, s60, 0x1120000
    s_addc_u32 s13, s61, 0
    s_mov_b32 s14, 0x3a080
    s_mov_b32 s15, 0x20000
    s_setprio 2
    v_mfma_f32_32x32x16_bf16 v[16:31], v[132:135], v[144:147], v[16:31]
    ds_read_b128 v[112:115], v156 offset:0
    ds_read_b64_tr_b16 v[116:117], v165 offset:0
    ds_read_b64_tr_b16 v[118:119], v165 offset:768
    ds_read_b128 v[120:123], v157 offset:0
    v_mfma_f32_32x32x16_bf16 v[32:47], v[132:135], v[148:151], v[32:47]
    ds_read_b64_tr_b16 v[124:125], v165 offset:3072
    ds_read_b64_tr_b16 v[126:127], v165 offset:3840
    ds_read_b128 v[128:131], v158 offset:0
    ds_read_b64_tr_b16 v[188:189], v165 offset:6144
    v_mfma_f32_32x32x16_bf16 v[48:63], v[136:139], v[144:147], v[48:63]
    ds_read_b64_tr_b16 v[190:191], v165 offset:6912
    ds_read_b128 v[192:195], v159 offset:0
    ds_read_b64_tr_b16 v[196:197], v165 offset:9216
    ds_read_b64_tr_b16 v[198:199], v165 offset:9984
    v_mfma_f32_32x32x16_bf16 v[64:79], v[136:139], v[148:151], v[64:79]
    ds_read_b128 v[200:203], v156 offset:4096
    ds_read_b128 v[224:227], v157 offset:4096
    ds_read_b128 v[228:231], v158 offset:4096
    ds_read_b128 v[232:235], v159 offset:4096
    v_mfma_f32_32x32x16_bf16 v[80:95], v[140:143], v[144:147], v[80:95]
    ds_read_b64_tr_b16 v[236:237], v165 offset:32
    ds_read_b64_tr_b16 v[238:239], v165 offset:800
    ds_read_b64_tr_b16 v[240:241], v165 offset:3104
    v_mfma_f32_32x32x16_bf16 v[96:111], v[140:143], v[148:151], v[96:111]
    ds_read_b64_tr_b16 v[242:243], v165 offset:3872
    ds_read_b64_tr_b16 v[244:245], v165 offset:6176
    ds_read_b64_tr_b16 v[246:247], v165 offset:6944
    s_waitcnt lgkmcnt(10)
    v_mfma_f32_32x32x16_bf16 v[16:31], v[116:119], v[112:115], v[16:31]
    ds_read_b64_tr_b16 v[248:249], v165 offset:9248
    ds_read_b64_tr_b16 v[250:251], v165 offset:10016
    ds_read_b64_tr_b16 v[252:253], v165 offset:64
    v_mfma_f32_32x32x16_bf16 v[16:31], v[124:127], v[120:123], v[16:31]
    ds_read_b64_tr_b16 v[254:255], v165 offset:832
    ds_read_b64_tr_b16 v[132:133], v165 offset:3136
    ds_read_b64_tr_b16 v[134:135], v165 offset:3904
    v_mfma_f32_32x32x16_bf16 v[16:31], v[188:191], v[128:131], v[16:31]
    ds_read_b64_tr_b16 v[136:137], v165 offset:6208
    ds_read_b64_tr_b16 v[138:139], v165 offset:6976
    ds_read_b64_tr_b16 v[140:141], v165 offset:9280
    v_mfma_f32_32x32x16_bf16 v[16:31], v[196:199], v[192:195], v[16:31]
    ds_read_b64_tr_b16 v[142:143], v165 offset:10048
    s_waitcnt lgkmcnt(15)
    v_mfma_f32_32x32x16_bf16 v[32:47], v[116:119], v[200:203], v[32:47]
    v_mfma_f32_32x32x16_bf16 v[32:47], v[124:127], v[224:227], v[32:47]
    v_mfma_f32_32x32x16_bf16 v[32:47], v[188:191], v[228:231], v[32:47]
    v_mfma_f32_32x32x16_bf16 v[32:47], v[196:199], v[232:235], v[32:47]
    s_waitcnt lgkmcnt(8)
    v_mfma_f32_32x32x16_bf16 v[48:63], v[236:239], v[112:115], v[48:63]
    s_nop 3
    v_mul_f32 v168, v16, v16
    v_mul_f32 v169, v17, v17
    v_mul_f32 v170, v18, v18
    v_mul_f32 v171, v19, v19
    v_mul_f32 v172, v20, v20
    v_mfma_f32_32x32x16_bf16 v[48:63], v[240:243], v[120:123], v[48:63]
    v_mul_f32 v173, v21, v21
    v_mul_f32 v174, v22, v22
    v_mul_f32 v175, v23, v23
    v_fma_f32 v168, v168, v206, v204
    v_fma_f32 v169, v169, v206, v204
    v_mfma_f32_32x32x16_bf16 v[48:63], v[244:247], v[128:131], v[48:63]
    v_fma_f32 v170, v170, v206, v204
    v_fma_f32 v171, v171, v206, v204
    v_fma_f32 v172, v172, v206, v204
    v_fma_f32 v173, v173, v206, v204
    v_fma_f32 v174, v174, v206, v204
    v_mfma_f32_32x32x16_bf16 v[48:63], v[248:251], v[192:195], v[48:63]
    v_fma_f32 v175, v175, v206, v204
    v_mul_f32 v168, v168, v16
    v_mul_f32 v169, v169, v17
    v_mul_f32 v170, v170, v18
    v_mul_f32 v171, v171, v19
    v_mfma_f32_32x32x16_bf16 v[64:79], v[236:239], v[200:203], v[64:79]
    v_mul_f32 v172, v172, v20
    v_mul_f32 v173, v173, v21
    v_mul_f32 v174, v174, v22
    v_mul_f32 v175, v175, v23
    v_exp_f32 v168, v168
    v_mfma_f32_32x32x16_bf16 v[64:79], v[240:243], v[224:227], v[64:79]
    v_mul_f32 v176, v16, v24
    v_exp_f32 v169, v169
    v_mul_f32 v177, v17, v25
    v_exp_f32 v170, v170
    v_mul_f32 v178, v18, v26
    v_mfma_f32_32x32x16_bf16 v[64:79], v[244:247], v[228:231], v[64:79]
    v_exp_f32 v171, v171
    v_mul_f32 v179, v19, v27
    v_exp_f32 v172, v172
    v_mul_f32 v180, v20, v28
    v_exp_f32 v173, v173
    v_mfma_f32_32x32x16_bf16 v[64:79], v[248:251], v[232:235], v[64:79]
    v_mul_f32 v181, v21, v29
    v_exp_f32 v174, v174
    v_mul_f32 v182, v22, v30
    v_exp_f32 v175, v175
    v_mul_f32 v183, v23, v31
    s_waitcnt lgkmcnt(0)
    v_mfma_f32_32x32x16_bf16 v[80:95], v[252:255], v[112:115], v[80:95]
    v_add_f32 v168, 1.0, v168
    v_add_f32 v169, 1.0, v169
    v_add_f32 v170, 1.0, v170
    v_add_f32 v171, 1.0, v171
    v_add_f32 v172, 1.0, v172
    v_mfma_f32_32x32x16_bf16 v[80:95], v[132:135], v[120:123], v[80:95]
    v_add_f32 v173, 1.0, v173
    v_add_f32 v174, 1.0, v174
    v_add_f32 v175, 1.0, v175
    v_rcp_f32 v168, v168
    v_rcp_f32 v169, v169
    v_mfma_f32_32x32x16_bf16 v[80:95], v[136:139], v[128:131], v[80:95]
    v_rcp_f32 v170, v170
    v_rcp_f32 v171, v171
    v_rcp_f32 v172, v172
    v_rcp_f32 v173, v173
    v_rcp_f32 v174, v174
    v_mfma_f32_32x32x16_bf16 v[80:95], v[140:143], v[192:195], v[80:95]
    v_rcp_f32 v175, v175
    v_mul_f32 v176, v176, v168
    v_mul_f32 v177, v177, v169
    v_mul_f32 v178, v178, v170
    v_mul_f32 v179, v179, v171
    v_mfma_f32_32x32x16_bf16 v[96:111], v[252:255], v[200:203], v[96:111]
    v_mul_f32 v180, v180, v172
    v_mul_f32 v181, v181, v173
    v_mul_f32 v182, v182, v174
    v_mul_f32 v183, v183, v175
    v_cvt_pk_bf16_f32 v16, v176, v177
    v_mfma_f32_32x32x16_bf16 v[96:111], v[132:135], v[224:227], v[96:111]
    v_cvt_pk_bf16_f32 v17, v178, v179
    v_cvt_pk_bf16_f32 v18, v180, v181
    v_cvt_pk_bf16_f32 v19, v182, v183
    s_add_u32 s72, s70, 0
    buffer_store_dwordx4 v[16:19], v9, s[16:19], s72 offen sc1
    v_pk_mul_f32 v[168:169], v[32:33], v[32:33]
    v_mfma_f32_32x32x16_bf16 v[96:111], v[136:139], v[228:231], v[96:111]
    v_pk_mul_f32 v[170:171], v[34:35], v[34:35]
    v_pk_mul_f32 v[172:173], v[36:37], v[36:37]
    v_pk_mul_f32 v[174:175], v[38:39], v[38:39]
    v_pk_fma_f32 v[168:169], v[168:169], v[206:207], v[204:205]
    v_pk_fma_f32 v[170:171], v[170:171], v[206:207], v[204:205]
    v_mfma_f32_32x32x16_bf16 v[96:111], v[140:143], v[232:235], v[96:111]
    v_pk_fma_f32 v[172:173], v[172:173], v[206:207], v[204:205]
    v_pk_fma_f32 v[174:175], v[174:175], v[206:207], v[204:205]
    v_pk_mul_f32 v[168:169], v[168:169], v[32:33]
    v_pk_mul_f32 v[170:171], v[170:171], v[34:35]
    v_pk_mul_f32 v[172:173], v[172:173], v[36:37]
    v_pk_mul_f32 v[174:175], v[174:175], v[38:39]
    v_exp_f32 v168, v168
    v_exp_f32 v169, v169
    v_exp_f32 v170, v170
    v_exp_f32 v171, v171
    v_exp_f32 v172, v172
    v_exp_f32 v173, v173
    v_exp_f32 v174, v174
    v_exp_f32 v175, v175
    v_pk_mul_f32 v[176:177], v[32:33], v[40:41]
    v_pk_mul_f32 v[178:179], v[34:35], v[42:43]
    v_pk_mul_f32 v[180:181], v[36:37], v[44:45]
    v_pk_mul_f32 v[182:183], v[38:39], v[46:47]
    v_pk_add_f32 v[168:169], v[168:169], v[208:209]
    v_pk_add_f32 v[170:171], v[170:171], v[208:209]
    v_pk_add_f32 v[172:173], v[172:173], v[208:209]
    v_pk_add_f32 v[174:175], v[174:175], v[208:209]
    v_rcp_f32 v168, v168
    v_rcp_f32 v169, v169
    v_rcp_f32 v170, v170
    v_rcp_f32 v171, v171
    v_rcp_f32 v172, v172
    v_rcp_f32 v173, v173
    v_rcp_f32 v174, v174
    v_rcp_f32 v175, v175
    v_pk_mul_f32 v[176:177], v[176:177], v[168:169]
    v_pk_mul_f32 v[178:179], v[178:179], v[170:171]
    v_pk_mul_f32 v[180:181], v[180:181], v[172:173]
    v_pk_mul_f32 v[182:183], v[182:183], v[174:175]
    v_cvt_pk_bf16_f32 v32, v176, v177
    v_cvt_pk_bf16_f32 v33, v178, v179
    v_cvt_pk_bf16_f32 v34, v180, v181
    v_cvt_pk_bf16_f32 v35, v182, v183
    s_add_u32 s72, s70, 88064
    buffer_store_dwordx4 v[32:35], v9, s[16:19], s72 offen sc1
    v_pk_mul_f32 v[168:169], v[48:49], v[48:49]
    v_pk_mul_f32 v[170:171], v[50:51], v[50:51]
    v_pk_mul_f32 v[172:173], v[52:53], v[52:53]
    v_pk_mul_f32 v[174:175], v[54:55], v[54:55]
    v_pk_fma_f32 v[168:169], v[168:169], v[206:207], v[204:205]
    v_pk_fma_f32 v[170:171], v[170:171], v[206:207], v[204:205]
    v_pk_fma_f32 v[172:173], v[172:173], v[206:207], v[204:205]
    v_pk_fma_f32 v[174:175], v[174:175], v[206:207], v[204:205]
    v_pk_mul_f32 v[168:169], v[168:169], v[48:49]
    v_pk_mul_f32 v[170:171], v[170:171], v[50:51]
    v_pk_mul_f32 v[172:173], v[172:173], v[52:53]
    v_pk_mul_f32 v[174:175], v[174:175], v[54:55]
    v_exp_f32 v168, v168
    v_exp_f32 v169, v169
    v_exp_f32 v170, v170
    v_exp_f32 v171, v171
    v_exp_f32 v172, v172
    v_exp_f32 v173, v173
    v_exp_f32 v174, v174
    v_exp_f32 v175, v175
    v_pk_mul_f32 v[176:177], v[48:49], v[56:57]
    v_pk_mul_f32 v[178:179], v[50:51], v[58:59]
    v_pk_mul_f32 v[180:181], v[52:53], v[60:61]
    v_pk_mul_f32 v[182:183], v[54:55], v[62:63]
    v_pk_add_f32 v[168:169], v[168:169], v[208:209]
    v_pk_add_f32 v[170:171], v[170:171], v[208:209]
    v_pk_add_f32 v[172:173], v[172:173], v[208:209]
    v_pk_add_f32 v[174:175], v[174:175], v[208:209]
    v_rcp_f32 v168, v168
    v_rcp_f32 v169, v169
    v_rcp_f32 v170, v170
    v_rcp_f32 v171, v171
    v_rcp_f32 v172, v172
    v_rcp_f32 v173, v173
    v_rcp_f32 v174, v174
    v_rcp_f32 v175, v175
    v_pk_mul_f32 v[176:177], v[176:177], v[168:169]
    v_pk_mul_f32 v[178:179], v[178:179], v[170:171]
    v_pk_mul_f32 v[180:181], v[180:181], v[172:173]
    v_pk_mul_f32 v[182:183], v[182:183], v[174:175]
    v_cvt_pk_bf16_f32 v48, v176, v177
    v_cvt_pk_bf16_f32 v49, v178, v179
    v_cvt_pk_bf16_f32 v50, v180, v181
    v_cvt_pk_bf16_f32 v51, v182, v183
    s_add_u32 s72, s70, 1024
    buffer_store_dwordx4 v[48:51], v9, s[16:19], s72 offen sc1
    v_pk_mul_f32 v[168:169], v[64:65], v[64:65]
    v_pk_mul_f32 v[170:171], v[66:67], v[66:67]
    v_pk_mul_f32 v[172:173], v[68:69], v[68:69]
    v_pk_mul_f32 v[174:175], v[70:71], v[70:71]
    v_pk_fma_f32 v[168:169], v[168:169], v[206:207], v[204:205]
    v_pk_fma_f32 v[170:171], v[170:171], v[206:207], v[204:205]
    v_pk_fma_f32 v[172:173], v[172:173], v[206:207], v[204:205]
    v_pk_fma_f32 v[174:175], v[174:175], v[206:207], v[204:205]
    v_pk_mul_f32 v[168:169], v[168:169], v[64:65]
    v_pk_mul_f32 v[170:171], v[170:171], v[66:67]
    v_pk_mul_f32 v[172:173], v[172:173], v[68:69]
    v_pk_mul_f32 v[174:175], v[174:175], v[70:71]
    v_exp_f32 v168, v168
    v_exp_f32 v169, v169
    v_exp_f32 v170, v170
    v_exp_f32 v171, v171
    v_exp_f32 v172, v172
    v_exp_f32 v173, v173
    v_exp_f32 v174, v174
    v_exp_f32 v175, v175
    v_pk_mul_f32 v[176:177], v[64:65], v[72:73]
    v_pk_mul_f32 v[178:179], v[66:67], v[74:75]
    v_pk_mul_f32 v[180:181], v[68:69], v[76:77]
    v_pk_mul_f32 v[182:183], v[70:71], v[78:79]
    v_pk_add_f32 v[168:169], v[168:169], v[208:209]
    v_pk_add_f32 v[170:171], v[170:171], v[208:209]
    v_pk_add_f32 v[172:173], v[172:173], v[208:209]
    v_pk_add_f32 v[174:175], v[174:175], v[208:209]
    v_rcp_f32 v168, v168
    v_rcp_f32 v169, v169
    v_rcp_f32 v170, v170
    v_rcp_f32 v171, v171
    v_rcp_f32 v172, v172
    v_rcp_f32 v173, v173
    v_rcp_f32 v174, v174
    v_rcp_f32 v175, v175
    v_pk_mul_f32 v[176:177], v[176:177], v[168:169]
    v_pk_mul_f32 v[178:179], v[178:179], v[170:171]
    v_pk_mul_f32 v[180:181], v[180:181], v[172:173]
    v_pk_mul_f32 v[182:183], v[182:183], v[174:175]
    v_cvt_pk_bf16_f32 v64, v176, v177
    v_cvt_pk_bf16_f32 v65, v178, v179
    v_cvt_pk_bf16_f32 v66, v180, v181
    v_cvt_pk_bf16_f32 v67, v182, v183
    s_add_u32 s72, s70, 89088
    buffer_store_dwordx4 v[64:67], v9, s[16:19], s72 offen sc1
    v_pk_mul_f32 v[168:169], v[80:81], v[80:81]
    v_pk_mul_f32 v[170:171], v[82:83], v[82:83]
    v_pk_mul_f32 v[172:173], v[84:85], v[84:85]
    v_pk_mul_f32 v[174:175], v[86:87], v[86:87]
    v_pk_fma_f32 v[168:169], v[168:169], v[206:207], v[204:205]
    v_pk_fma_f32 v[170:171], v[170:171], v[206:207], v[204:205]
    v_pk_fma_f32 v[172:173], v[172:173], v[206:207], v[204:205]
    v_pk_fma_f32 v[174:175], v[174:175], v[206:207], v[204:205]
    v_pk_mul_f32 v[168:169], v[168:169], v[80:81]
    v_pk_mul_f32 v[170:171], v[170:171], v[82:83]
    v_pk_mul_f32 v[172:173], v[172:173], v[84:85]
    v_pk_mul_f32 v[174:175], v[174:175], v[86:87]
    v_exp_f32 v168, v168
    v_exp_f32 v169, v169
    v_exp_f32 v170, v170
    v_exp_f32 v171, v171
    v_exp_f32 v172, v172
    v_exp_f32 v173, v173
    v_exp_f32 v174, v174
    v_exp_f32 v175, v175
    v_pk_mul_f32 v[176:177], v[80:81], v[88:89]
    v_pk_mul_f32 v[178:179], v[82:83], v[90:91]
    v_pk_mul_f32 v[180:181], v[84:85], v[92:93]
    v_pk_mul_f32 v[182:183], v[86:87], v[94:95]
    v_pk_add_f32 v[168:169], v[168:169], v[208:209]
    v_pk_add_f32 v[170:171], v[170:171], v[208:209]
    v_pk_add_f32 v[172:173], v[172:173], v[208:209]
    v_pk_add_f32 v[174:175], v[174:175], v[208:209]
    v_rcp_f32 v168, v168
    v_rcp_f32 v169, v169
    v_rcp_f32 v170, v170
    v_rcp_f32 v171, v171
    v_rcp_f32 v172, v172
    v_rcp_f32 v173, v173
    v_rcp_f32 v174, v174
    v_rcp_f32 v175, v175
    v_pk_mul_f32 v[176:177], v[176:177], v[168:169]
    v_pk_mul_f32 v[178:179], v[178:179], v[170:171]
    v_pk_mul_f32 v[180:181], v[180:181], v[172:173]
    v_pk_mul_f32 v[182:183], v[182:183], v[174:175]
    v_cvt_pk_bf16_f32 v80, v176, v177
    v_cvt_pk_bf16_f32 v81, v178, v179
    v_cvt_pk_bf16_f32 v82, v180, v181
    v_cvt_pk_bf16_f32 v83, v182, v183
    s_cmp_ge_u32 s71, 84
    s_cbranch_scc1 nost8
    s_add_u32 s72, s70, 2048
    buffer_store_dwordx4 v[80:83], v9, s[16:19], s72 offen sc1
nost8:
    v_pk_mul_f32 v[168:169], v[96:97], v[96:97]
    v_pk_mul_f32 v[170:171], v[98:99], v[98:99]
    v_pk_mul_f32 v[172:173], v[100:101], v[100:101]
    v_pk_mul_f32 v[174:175], v[102:103], v[102:103]
    v_pk_fma_f32 v[168:169], v[168:169], v[206:207], v[204:205]
    v_pk_fma_f32 v[170:171], v[170:171], v[206:207], v[204:205]
    v_pk_fma_f32 v[172:173], v[172:173], v[206:207], v[204:205]
    v_pk_fma_f32 v[174:175], v[174:175], v[206:207], v[204:205]
    v_pk_mul_f32 v[168:169], v[168:169], v[96:97]
    v_pk_mul_f32 v[170:171], v[170:171], v[98:99]
    v_pk_mul_f32 v[172:173], v[172:173], v[100:101]
    v_pk_mul_f32 v[174:175], v[174:175], v[102:103]
    v_exp_f32 v168, v168
    v_exp_f32 v169, v169
    v_exp_f32 v170, v170
    v_exp_f32 v171, v171
    v_exp_f32 v172, v172
    v_exp_f32 v173, v173
    v_exp_f32 v174, v174
    v_exp_f32 v175, v175
    v_pk_mul_f32 v[176:177], v[96:97], v[104:105]
    v_pk_mul_f32 v[178:179], v[98:99], v[106:107]
    v_pk_mul_f32 v[180:181], v[100:101], v[108:109]
    v_pk_mul_f32 v[182:183], v[102:103], v[110:111]
    v_pk_add_f32 v[168:169], v[168:169], v[208:209]
    v_pk_add_f32 v[170:171], v[170:171], v[208:209]
    v_pk_add_f32 v[172:173], v[172:173], v[208:209]
    v_pk_add_f32 v[174:175], v[174:175], v[208:209]
    v_rcp_f32 v168, v168
    v_rcp_f32 v169, v169
    v_rcp_f32 v170, v170
    v_rcp_f32 v171, v171
    v_rcp_f32 v172, v172
    v_rcp_f32 v173, v173
    v_rcp_f32 v174, v174
    v_rcp_f32 v175, v175
    v_pk_mul_f32 v[176:177], v[176:177], v[168:169]
    v_pk_mul_f32 v[178:179], v[178:179], v[170:171]
    v_pk_mul_f32 v[180:181], v[180:181], v[172:173]
    v_pk_mul_f32 v[182:183], v[182:183], v[174:175]
    v_cvt_pk_bf16_f32 v96, v176, v177
    v_cvt_pk_bf16_f32 v97, v178, v179
    v_cvt_pk_bf16_f32 v98, v180, v181
    v_cvt_pk_bf16_f32 v99, v182, v183
    s_cmp_ge_u32 s71, 84
    s_cbranch_scc1 nost9
    s_add_u32 s72, s70, 90112
    buffer_store_dwordx4 v[96:99], v9, s[16:19], s72 offen sc1
nost9:
    s_setprio 0
A_compute_done:
A_post:
    s_mov_b64 exec, 1
    v_mov_b32 v12, 34100
    v_mov_b32 v13, 1
    ds_add_u32 v12, v13
    s_mov_b64 exec, -1
A_post2:
    v_mov_b32 v182, 34076
    ds_read_b32 v183, v182
    v_lshlrev_b32 v2, 4, v1
    v_and_b32 v10, 15, v1
    v_lshrrev_b32 v11, 4, v1
    s_lshr_b32 s20, s77, 1
    s_and_b32 s21, s77, 1
    v_and_b32 v12, 1, v10
    v_mul_u32_u24 v12, 4160, v12
    v_lshrrev_b32 v13, 1, v10
    v_lshlrev_b32 v14, 2, v11
    v_sub_u32 v13, v14, v13
    v_lshl_add_u32 v12, v13, 2, v12
    s_mul_i32 s22, s20, 8320
    s_lshl_b32 s23, s21, 8
    s_sub_u32 s22, s22, s23
    s_add_u32 s22, s22, 20764
    v_add_u32 v4, s22, v12
    v_subrev_u32 v5, 1024, v4
    v_subrev_u32 v6, 2048, v4
    v_subrev_u32 v7, 3072, v4
    s_mul_i32 s22, s20, 4608
    s_add_u32 s22, s22, 34816
    v_lshlrev_b32 v9, 5, v10
    v_lshl_add_u32 v9, v11, 3, v9
    v_add_u32 v9, s22, v9
    s_lshl_b32 s24, s21, 9
    s_add_u32 s24, s24, 480
    v_add_u32 v9, s24, v9
    s_sub_u32 s22, s22, s23
    s_add_u32 s22, s22, 256
    v_lshlrev_b32 v12, 5, v10
    v_lshl_add_u32 v12, v11, 4, v12
    v_add_u32 v8, s22, v12
    s_lshl_b32 s22, s77, 12
    s_xor_b32 s23, s22, 4096
    s_add_u32 s22, s22, 0
    s_add_u32 s23, s23, 0
    v_add_u32 v176, s22, v2
    v_add_u32 v177, s23, v2
    s_lshl_b32 s22, s77, 2
    s_add_u32 s22, s22, 34048
    v_mov_b32 v178, s22
    v_xor_b32 v179, 4, v178
    v_mov_b32 v180, 1
    v_and_b32 v15, 15, v1
    v_lshlrev_b32 v15, 5, v15
    s_lshl_b32 s22, s21, 10
    s_sub_u32 s22, 1536, s22
    v_add_u32 v3, s22, v9
    v_bfe_u32 v14, v1, 4, 1
    v_mad_u32_u24 v15, v14, s22, v15
    v_lshrrev_b32 v14, 5, v1
    v_lshl_add_u32 v15, v14, 4, v15
    s_lshl_b32 s26, s66, 1
    s_add_u32 s26, s26, s20
    s_mul_i32 s26, s26, 4224
    s_lshl_b32 s23, s21, 9
    s_add_u32 s26, s26, s23
    v_lshlrev_b32 v220, 16, v220
    v_mov_b32 v221, v220
    s_add_u32 s4, s60, 0xc00000
    s_addc_u32 s5, s61, 0
    s_mov_b32 s6, 0x210000
    s_mov_b32 s7, 0x20000
    s_waitcnt lgkmcnt(0)
    v_readfirstlane_b32 s22, v183
    s_cmp_ge_u32 s22, 4
    s_cbranch_scc1 rdy10
    s_waitcnt vmcnt(0)
    s_mov_b32 s22, s25
    v_mov_b32 v10, s30
    v_mov_b32 v11, s31
    v_mov_b32 v12, 0
    s_mov_b64 exec, 1
    buffer_store_dwordx2 v[10:11], v12, s[12:15], s22 offen sc1
    s_mov_b64 exec, -1
    v_mov_b32 v12, 34076
lw11:
    ds_read_b32 v13, v12
    s_waitcnt lgkmcnt(0)
    v_readfirstlane_b32 s22, v13
    s_cmp_ge_u32 s22, 4
    s_cbranch_scc1 lwok11
    s_sub_u32 s101, s101, 1
    s_cmp_lt_i32 s101, 0
    s_cbranch_scc1 lwok11
    s_branch lw11
lwok11:
    ds_read2_b32 v[48:49], v4 offset0:176 offset1:177
    ds_read2_b32 v[50:51], v4 offset0:178 offset1:179
    ds_read_b128 v[80:83], v8 offset:192
    ds_read2_b32 v[52:53], v4 offset0:48 offset1:49
    ds_read2_b32 v[54:55], v4 offset0:50 offset1:51
    ds_read_b128 v[84:87], v8 offset:704
    ds_read2_b32 v[56:57], v5 offset0:176 offset1:177
    ds_read2_b32 v[58:59], v5 offset0:178 offset1:179
    ds_read_b128 v[88:91], v8 offset:1216
    ds_read2_b32 v[60:61], v5 offset0:48 offset1:49
    ds_read2_b32 v[62:63], v5 offset0:50 offset1:51
    ds_read_b128 v[92:95], v8 offset:1728
    ds_read2_b32 v[64:65], v6 offset0:176 offset1:177
    ds_read2_b32 v[66:67], v6 offset0:178 offset1:179
    ds_read_b128 v[96:99], v8 offset:2240
    ds_read2_b32 v[68:69], v6 offset0:48 offset1:49
    ds_read2_b32 v[70:71], v6 offset0:50 offset1:51
    ds_read_b128 v[100:103], v8 offset:2752
    ds_read2_b32 v[72:73], v7 offset0:176 offset1:177
    ds_read2_b32 v[74:75], v7 offset0:178 offset1:179
    ds_read_b128 v[104:107], v8 offset:3264
    ds_read2_b32 v[76:77], v7 offset0:48 offset1:49
    ds_read2_b32 v[78:79], v7 offset0:50 offset1:51
    ds_read_b128 v[108:111], v8 offset:3776
    s_branch go10
rdy10:
    ds_read2_b32 v[48:49], v4 offset0:176 offset1:177
    ds_read2_b32 v[50:51], v4 offset0:178 offset1:179
    ds_read_b128 v[80:83], v8 offset:192
    ds_read2_b32 v[52:53], v4 offset0:48 offset1:49
    ds_read2_b32 v[54:55], v4 offset0:50 offset1:51
    ds_read_b128 v[84:87], v8 offset:704
    ds_read2_b32 v[56:57], v5 offset0:176 offset1:177
    ds_read2_b32 v[58:59], v5 offset0:178 offset1:179
    ds_read_b128 v[88:91], v8 offset:1216
    ds_read2_b32 v[60:61], v5 offset0:48 offset1:49
    ds_read2_b32 v[62:63], v5 offset0:50 offset1:51
    ds_read_b128 v[92:95], v8 offset:1728
    ds_read2_b32 v[64:65], v6 offset0:176 offset1:177
    ds_read2_b32 v[66:67], v6 offset0:178 offset1:179
    ds_read_b128 v[96:99], v8 offset:2240
    ds_read2_b32 v[68:69], v6 offset0:48 offset1:49
    ds_read2_b32 v[70:71], v6 offset0:50 offset1:51
    ds_read_b128 v[100:103], v8 offset:2752
    ds_read2_b32 v[72:73], v7 offset0:176 offset1:177
    ds_read2_b32 v[74:75], v7 offset0:178 offset1:179
    ds_read_b128 v[104:107], v8 offset:3264
    ds_read2_b32 v[76:77], v7 offset0:48 offset1:49
    ds_read2_b32 v[78:79], v7 offset0:50 offset1:51
    ds_read_b128 v[108:111], v8 offset:3776
    s_waitcnt vmcnt(0)
    s_mov_b32 s22, s25
    v_mov_b32 v10, s30
    v_mov_b32 v11, s31
    v_mov_b32 v12, 0
    s_mov_b64 exec, 1
    buffer_store_dwordx2 v[10:11], v12, s[12:15], s22 offen sc1
    s_mov_b64 exec, -1
go10:
    s_waitcnt lgkmcnt(15)
    v_mfma_f32_16x16x32_bf16 v[16:19], v[48:51], v[80:83], 0
    s_waitcnt lgkmcnt(15)
    v_mfma_f32_16x16x32_bf16 v[20:23], v[48:51], v[84:87], 0
    v_mfma_f32_16x16x32_bf16 v[20:23], v[52:55], v[80:83], v[20:23]
    v_mfma_f32_16x16x32_bf16 v[24:27], v[52:55], v[84:87], 0
    s_waitcnt lgkmcnt(15)
    v_mfma_f32_16x16x32_bf16 v[24:27], v[48:51], v[88:91], v[24:27]
    v_mfma_f32_16x16x32_bf16 v[28:31], v[52:55], v[88:91], 0
    v_mfma_f32_16x16x32_bf16 v[24:27], v[56:59], v[80:83], v[24:27]
    v_mfma_f32_16x16x32_bf16 v[28:31], v[56:59], v[84:87], v[28:31]
    v_mfma_f32_16x16x32_bf16 v[32:35], v[56:59], v[88:91], 0
    ds_read2_b32 v[112:113], v4 offset0:160 offset1:161
    s_waitcnt lgkmcnt(13)
    v_mfma_f32_16x16x32_bf16 v[28:31], v[48:51], v[92:95], v[28:31]
    ds_read2_b32 v[114:115], v4 offset0:162 offset1:163
    v_mfma_f32_16x16x32_bf16 v[32:35], v[52:55], v[92:95], v[32:35]
    ds_read_b128 v[144:147], v8 offset:128
    v_mfma_f32_16x16x32_bf16 v[36:39], v[56:59], v[92:95], 0
    ds_read2_b32 v[116:117], v4 offset0:32 offset1:33
    v_mfma_f32_16x16x32_bf16 v[28:31], v[60:63], v[80:83], v[28:31]
    ds_read2_b32 v[118:119], v4 offset0:34 offset1:35
    v_mfma_f32_16x16x32_bf16 v[32:35], v[60:63], v[84:87], v[32:35]
    ds_read_b128 v[148:151], v8 offset:640
    v_mfma_f32_16x16x32_bf16 v[36:39], v[60:63], v[88:91], v[36:39]
    ds_read2_b32 v[120:121], v5 offset0:160 offset1:161
    v_mfma_f32_16x16x32_bf16 v[40:43], v[60:63], v[92:95], 0
    ds_read2_b32 v[122:123], v5 offset0:162 offset1:163
    s_waitcnt lgkmcnt(15)
    v_mfma_f32_16x16x32_bf16 v[32:35], v[48:51], v[96:99], v[32:35]
    ds_read_b128 v[152:155], v8 offset:1152
    v_mfma_f32_16x16x32_bf16 v[36:39], v[52:55], v[96:99], v[36:39]
    ds_read2_b32 v[124:125], v5 offset0:32 offset1:33
    v_mfma_f32_16x16x32_bf16 v[40:43], v[56:59], v[96:99], v[40:43]
    ds_read2_b32 v[126:127], v5 offset0:34 offset1:35
    v_mfma_f32_16x16x32_bf16 v[44:47], v[60:63], v[96:99], 0
    ds_read_b128 v[156:159], v8 offset:1664
    v_mfma_f32_16x16x32_bf16 v[32:35], v[64:67], v[80:83], v[32:35]
    ds_read2_b32 v[128:129], v6 offset0:160 offset1:161
    v_mfma_f32_16x16x32_bf16 v[36:39], v[64:67], v[84:87], v[36:39]
    ds_read2_b32 v[130:131], v6 offset0:162 offset1:163
    v_mfma_f32_16x16x32_bf16 v[40:43], v[64:67], v[88:91], v[40:43]
    ds_read_b128 v[160:163], v8 offset:2176
    v_mfma_f32_16x16x32_bf16 v[44:47], v[64:67], v[92:95], v[44:47]
    ds_read2_b32 v[132:133], v6 offset0:32 offset1:33
    s_waitcnt lgkmcnt(15)
    v_mfma_f32_16x16x32_bf16 v[36:39], v[48:51], v[100:103], v[36:39]
    ds_read2_b32 v[134:135], v6 offset0:34 offset1:35
    v_mfma_f32_16x16x32_bf16 v[40:43], v[52:55], v[100:103], v[40:43]
    ds_read_b128 v[164:167], v8 offset:2688
    v_mfma_f32_16x16x32_bf16 v[44:47], v[56:59], v[100:103], v[44:47]
    ds_read2_b32 v[136:137], v7 offset0:160 offset1:161
    v_mfma_f32_16x16x32_bf16 v[36:39], v[68:71], v[80:83], v[36:39]
    ds_read2_b32 v[138:139], v7 offset0:162 offset1:163
    v_mfma_f32_16x16x32_bf16 v[40:43], v[68:71], v[84:87], v[40:43]
    ds_read_b128 v[168:171], v8 offset:3200
    v_mfma_f32_16x16x32_bf16 v[44:47], v[68:71], v[88:91], v[44:47]
    ds_read2_b32 v[140:141], v7 offset0:32 offset1:33
    s_waitcnt lgkmcnt(15)
    v_mfma_f32_16x16x32_bf16 v[40:43], v[48:51], v[104:107], v[40:43]
    ds_read2_b32 v[142:143], v7 offset0:34 offset1:35
    v_mfma_f32_16x16x32_bf16 v[44:47], v[52:55], v[104:107], v[44:47]
    ds_read_b128 v[172:175], v8 offset:3712
    v_mfma_f32_16x16x32_bf16 v[40:43], v[72:75], v[80:83], v[40:43]
    ds_read_b64 v[184:185], v9 offset:0
    v_mfma_f32_16x16x32_bf16 v[44:47], v[72:75], v[84:87], v[44:47]
    ds_read_b64 v[186:187], v3 offset:0
    s_waitcnt lgkmcnt(15)
    v_mfma_f32_16x16x32_bf16 v[44:47], v[48:51], v[108:111], v[44:47]
    ds_read_b64 v[188:189], v9 offset:2048
    v_mfma_f32_16x16x32_bf16 v[44:47], v[76:79], v[80:83], v[44:47]
    ds_read_b64 v[190:191], v3 offset:2048
    s_waitcnt lgkmcnt(15)
    v_mfma_f32_16x16x32_bf16 v[16:19], v[112:115], v[144:147], v[16:19]
    s_waitcnt lgkmcnt(15)
    v_mfma_f32_16x16x32_bf16 v[20:23], v[112:115], v[148:151], v[20:23]
    v_mfma_f32_16x16x32_bf16 v[20:23], v[116:119], v[144:147], v[20:23]
    v_mfma_f32_16x16x32_bf16 v[24:27], v[116:119], v[148:151], v[24:27]
    s_waitcnt lgkmcnt(15)
    v_mfma_f32_16x16x32_bf16 v[24:27], v[112:115], v[152:155], v[24:27]
    v_mfma_f32_16x16x32_bf16 v[28:31], v[116:119], v[152:155], v[28:31]
    v_mfma_f32_16x16x32_bf16 v[24:27], v[120:123], v[144:147], v[24:27]
    v_mfma_f32_16x16x32_bf16 v[28:31], v[120:123], v[148:151], v[28:31]
    v_mfma_f32_16x16x32_bf16 v[32:35], v[120:123], v[152:155], v[32:35]
    ds_read2_b32 v[48:49], v4 offset0:144 offset1:145
    s_waitcnt lgkmcnt(15)
    v_mfma_f32_16x16x32_bf16 v[28:31], v[112:115], v[156:159], v[28:31]
    ds_read2_b32 v[50:51], v4 offset0:146 offset1:147
    v_mfma_f32_16x16x32_bf16 v[32:35], v[116:119], v[156:159], v[32:35]
    ds_read_b128 v[80:83], v8 offset:64
    v_mfma_f32_16x16x32_bf16 v[36:39], v[120:123], v[156:159], v[36:39]
    ds_read2_b32 v[52:53], v4 offset0:16 offset1:17
    v_mfma_f32_16x16x32_bf16 v[28:31], v[124:127], v[144:147], v[28:31]
    ds_read2_b32 v[54:55], v4 offset0:18 offset1:19
    v_mfma_f32_16x16x32_bf16 v[32:35], v[124:127], v[148:151], v[32:35]
    ds_read_b128 v[84:87], v8 offset:576
    v_mfma_f32_16x16x32_bf16 v[36:39], v[124:127], v[152:155], v[36:39]
    ds_read2_b32 v[56:57], v5 offset0:144 offset1:145
    v_mfma_f32_16x16x32_bf16 v[40:43], v[124:127], v[156:159], v[40:43]
    ds_read2_b32 v[58:59], v5 offset0:146 offset1:147
    s_waitcnt lgkmcnt(15)
    v_mfma_f32_16x16x32_bf16 v[32:35], v[112:115], v[160:163], v[32:35]
    ds_read_b128 v[88:91], v8 offset:1088
    v_mfma_f32_16x16x32_bf16 v[36:39], v[116:119], v[160:163], v[36:39]
    ds_read2_b32 v[60:61], v5 offset0:16 offset1:17
    v_mfma_f32_16x16x32_bf16 v[40:43], v[120:123], v[160:163], v[40:43]
    ds_read2_b32 v[62:63], v5 offset0:18 offset1:19
    v_mfma_f32_16x16x32_bf16 v[44:47], v[124:127], v[160:163], v[44:47]
    ds_read_b128 v[92:95], v8 offset:1600
    v_mfma_f32_16x16x32_bf16 v[32:35], v[128:131], v[144:147], v[32:35]
    ds_read2_b32 v[64:65], v6 offset0:144 offset1:145
    v_mfma_f32_16x16x32_bf16 v[36:39], v[128:131], v[148:151], v[36:39]
    ds_read2_b32 v[66:67], v6 offset0:146 offset1:147
    v_mfma_f32_16x16x32_bf16 v[40:43], v[128:131], v[152:155], v[40:43]
    ds_read_b128 v[96:99], v8 offset:2112
    v_mfma_f32_16x16x32_bf16 v[44:47], v[128:131], v[156:159], v[44:47]
    ds_read2_b32 v[68:69], v6 offset0:16 offset1:17
    s_waitcnt lgkmcnt(15)
    v_mfma_f32_16x16x32_bf16 v[36:39], v[112:115], v[164:167], v[36:39]
    ds_read2_b32 v[70:71], v6 offset0:18 offset1:19
    v_mfma_f32_16x16x32_bf16 v[40:43], v[116:119], v[164:167], v[40:43]
    ds_read_b128 v[100:103], v8 offset:2624
    v_mfma_f32_16x16x32_bf16 v[44:47], v[120:123], v[164:167], v[44:47]
    ds_read2_b32 v[72:73], v7 offset0:144 offset1:145
    v_mfma_f32_16x16x32_bf16 v[36:39], v[132:135], v[144:147], v[36:39]
    ds_read2_b32 v[74:75], v7 offset0:146 offset1:147
    v_mfma_f32_16x16x32_bf16 v[40:43], v[132:135], v[148:151], v[40:43]
    ds_read_b128 v[104:107], v8 offset:3136
    v_mfma_f32_16x16x32_bf16 v[44:47], v[132:135], v[152:155], v[44:47]
    ds_read2_b32 v[76:77], v7 offset0:16 offset1:17
    s_waitcnt lgkmcnt(15)
    v_mfma_f32_16x16x32_bf16 v[40:43], v[112:115], v[168:171], v[40:43]
    ds_read2_b32 v[78:79], v7 offset0:18 offset1:19
    v_mfma_f32_16x16x32_bf16 v[44:47], v[116:119], v[168:171], v[44:47]
    ds_read_b128 v[108:111], v8 offset:3648
    v_mfma_f32_16x16x32_bf16 v[40:43], v[136:139], v[144:147], v[40:43]
    v_mfma_f32_16x16x32_bf16 v[44:47], v[136:139], v[148:151], v[44:47]
    s_waitcnt lgkmcnt(15)
    v_mfma_f32_16x16x32_bf16 v[44:47], v[112:115], v[172:175], v[44:47]
    v_mfma_f32_16x16x32_bf16 v[44:47], v[140:143], v[144:147], v[44:47]
    s_waitcnt lgkmcnt(15)
    v_mfma_f32_16x16x32_bf16 v[16:19], v[48:51], v[80:83], v[16:19]
    s_waitcnt lgkmcnt(15)
    v_mfma_f32_16x16x32_bf16 v[20:23], v[48:51], v[84:87], v[20:23]
    v_mfma_f32_16x16x32_bf16 v[20:23], v[52:55], v[80:83], v[20:23]
    ds_read2_b32 v[112:113], v4 offset0:128 offset1:129
    v_mfma_f32_16x16x32_bf16 v[24:27], v[52:55], v[84:87], v[24:27]
    ds_read2_b32 v[114:115], v4 offset0:130 offset1:131
    s_waitcnt lgkmcnt(15)
    v_mfma_f32_16x16x32_bf16 v[24:27], v[48:51], v[88:91], v[24:27]
    ds_read_b128 v[144:147], v8 offset:0
    v_mfma_f32_16x16x32_bf16 v[28:31], v[52:55], v[88:91], v[28:31]
    ds_read2_b32 v[116:117], v4 offset0:0 offset1:1
    v_mfma_f32_16x16x32_bf16 v[24:27], v[56:59], v[80:83], v[24:27]
    ds_read2_b32 v[118:119], v4 offset0:2 offset1:3
    v_mfma_f32_16x16x32_bf16 v[28:31], v[56:59], v[84:87], v[28:31]
    ds_read_b128 v[148:151], v8 offset:512
    v_mfma_f32_16x16x32_bf16 v[32:35], v[56:59], v[88:91], v[32:35]
    ds_read2_b32 v[120:121], v5 offset0:128 offset1:129
    s_waitcnt lgkmcnt(15)
    v_mfma_f32_16x16x32_bf16 v[28:31], v[48:51], v[92:95], v[28:31]
    ds_read2_b32 v[122:123], v5 offset0:130 offset1:131
    v_mfma_f32_16x16x32_bf16 v[32:35], v[52:55], v[92:95], v[32:35]
    ds_read_b128 v[152:155], v8 offset:1024
    v_mfma_f32_16x16x32_bf16 v[36:39], v[56:59], v[92:95], v[36:39]
    ds_read2_b32 v[124:125], v5 offset0:0 offset1:1
    v_mfma_f32_16x16x32_bf16 v[28:31], v[60:63], v[80:83], v[28:31]
    ds_read2_b32 v[126:127], v5 offset0:2 offset1:3
    v_mfma_f32_16x16x32_bf16 v[32:35], v[60:63], v[84:87], v[32:35]
    ds_read_b128 v[156:159], v8 offset:1536
    v_mfma_f32_16x16x32_bf16 v[36:39], v[60:63], v[88:91], v[36:39]
    ds_read2_b32 v[128:129], v6 offset0:128 offset1:129
    v_mfma_f32_16x16x32_bf16 v[40:43], v[60:63], v[92:95], v[40:43]
    ds_read2_b32 v[130:131], v6 offset0:130 offset1:131
    s_waitcnt lgkmcnt(15)
    v_mfma_f32_16x16x32_bf16 v[32:35], v[48:51], v[96:99], v[32:35]
    ds_read_b128 v[160:163], v8 offset:2048
    v_mfma_f32_16x16x32_bf16 v[36:39], v[52:55], v[96:99], v[36:39]
    ds_read2_b32 v[132:133], v6 offset0:0 offset1:1
    v_mfma_f32_16x16x32_bf16 v[40:43], v[56:59], v[96:99], v[40:43]
    ds_read2_b32 v[134:135], v6 offset0:2 offset1:3
    v_mfma_f32_16x16x32_bf16 v[44:47], v[60:63], v[96:99], v[44:47]
    ds_read_b128 v[164:167], v8 offset:2560
    v_mfma_f32_16x16x32_bf16 v[32:35], v[64:67], v[80:83], v[32:35]
    ds_read2_b32 v[136:137], v7 offset0:128 offset1:129
    v_lshlrev_b32 v192, 16, v184
    v_mfma_f32_16x16x32_bf16 v[36:39], v[64:67], v[84:87], v[36:39]
    ds_read2_b32 v[138:139], v7 offset0:130 offset1:131
    v_and_b32 v193, 0xffff0000, v184
    v_mfma_f32_16x16x32_bf16 v[40:43], v[64:67], v[88:91], v[40:43]
    ds_read_b128 v[168:171], v8 offset:3072
    v_lshlrev_b32 v194, 16, v185
    v_mfma_f32_16x16x32_bf16 v[44:47], v[64:67], v[92:95], v[44:47]
    ds_read2_b32 v[140:141], v7 offset0:0 offset1:1
    v_and_b32 v195, 0xffff0000, v185
    s_waitcnt lgkmcnt(15)
    v_mfma_f32_16x16x32_bf16 v[36:39], v[48:51], v[100:103], v[36:39]
    ds_read2_b32 v[142:143], v7 offset0:2 offset1:3
    v_lshlrev_b32 v196, 16, v186
    v_mfma_f32_16x16x32_bf16 v[40:43], v[52:55], v[100:103], v[40:43]
    ds_read_b128 v[172:175], v8 offset:3584
    v_and_b32 v197, 0xffff0000, v186
    v_mfma_f32_16x16x32_bf16 v[44:47], v[56:59], v[100:103], v[44:47]
    v_lshlrev_b32 v198, 16, v187
    v_mfma_f32_16x16x32_bf16 v[36:39], v[68:71], v[80:83], v[36:39]
    v_and_b32 v199, 0xffff0000, v187
    v_mfma_f32_16x16x32_bf16 v[40:43], v[68:71], v[84:87], v[40:43]
    v_lshlrev_b32 v200, 16, v188
    v_mfma_f32_16x16x32_bf16 v[44:47], v[68:71], v[88:91], v[44:47]
    v_and_b32 v201, 0xffff0000, v188
    s_waitcnt lgkmcnt(15)
    v_mfma_f32_16x16x32_bf16 v[40:43], v[48:51], v[104:107], v[40:43]
    v_lshlrev_b32 v202, 16, v189
    v_mfma_f32_16x16x32_bf16 v[44:47], v[52:55], v[104:107], v[44:47]
    v_and_b32 v203, 0xffff0000, v189
    v_mfma_f32_16x16x32_bf16 v[40:43], v[72:75], v[80:83], v[40:43]
    v_lshlrev_b32 v204, 16, v190
    v_mfma_f32_16x16x32_bf16 v[44:47], v[72:75], v[84:87], v[44:47]
    v_and_b32 v205, 0xffff0000, v190
    s_waitcnt lgkmcnt(15)
    v_mfma_f32_16x16x32_bf16 v[44:47], v[48:51], v[108:111], v[44:47]
    v_lshlrev_b32 v206, 16, v191
    v_mfma_f32_16x16x32_bf16 v[44:47], v[76:79], v[80:83], v[44:47]
    v_and_b32 v207, 0xffff0000, v191
    s_waitcnt lgkmcnt(0)
    s_cmp_lg_u32 s21, 0
    s_cbranch_scc1 cv1_12
    v_mfma_f32_16x16x32_bf16 v[40:43], v[136:139], v[144:147], v[40:43]
    v_mfma_f32_16x16x32_bf16 v[36:39], v[132:135], v[144:147], v[36:39]
    v_mfma_f32_16x16x32_bf16 v[40:43], v[132:135], v[148:151], v[40:43]
    v_mfma_f32_16x16x32_bf16 v[36:39], v[128:131], v[148:151], v[36:39]
    v_mfma_f32_16x16x32_bf16 v[40:43], v[128:131], v[152:155], v[40:43]
    v_mfma_f32_16x16x32_bf16 v[36:39], v[124:127], v[152:155], v[36:39]
    v_mfma_f32_16x16x32_bf16 v[40:43], v[124:127], v[156:159], v[40:43]
    v_fmac_f32 v16, v192, v220
    v_fmac_f32 v17, v193, v220
    v_mfma_f32_16x16x32_bf16 v[24:27], v[120:123], v[144:147], v[24:27]
    v_fmac_f32 v18, v194, v220
    v_fmac_f32 v19, v195, v220
    v_mfma_f32_16x16x32_bf16 v[36:39], v[120:123], v[156:159], v[36:39]
    v_fmac_f32 v28, v196, v220
    v_fmac_f32 v29, v197, v220
    v_mfma_f32_16x16x32_bf16 v[40:43], v[120:123], v[160:163], v[40:43]
    v_fmac_f32 v30, v198, v220
    v_fmac_f32 v31, v199, v220
    v_mfma_f32_16x16x32_bf16 v[20:23], v[116:119], v[144:147], v[20:23]
    v_fmac_f32 v32, v200, v220
    v_fmac_f32 v33, v201, v220
    v_mfma_f32_16x16x32_bf16 v[24:27], v[116:119], v[148:151], v[24:27]
    v_fmac_f32 v34, v202, v220
    v_fmac_f32 v35, v203, v220
    v_mfma_f32_16x16x32_bf16 v[36:39], v[116:119], v[160:163], v[36:39]
    v_fmac_f32 v44, v204, v220
    v_fmac_f32 v45, v205, v220
    v_mfma_f32_16x16x32_bf16 v[40:43], v[116:119], v[164:167], v[40:43]
    v_fmac_f32 v46, v206, v220
    v_fmac_f32 v47, v207, v220
    v_mfma_f32_16x16x32_bf16 v[20:23], v[112:115], v[148:151], v[20:23]
    v_mfma_f32_16x16x32_bf16 v[24:27], v[112:115], v[152:155], v[24:27]
    v_mfma_f32_16x16x32_bf16 v[36:39], v[112:115], v[164:167], v[36:39]
    v_mfma_f32_16x16x32_bf16 v[40:43], v[112:115], v[168:171], v[40:43]
    v_mfma_f32_16x16x32_bf16 v[44:47], v[140:143], v[144:147], v[44:47]
    v_mfma_f32_16x16x32_bf16 v[32:35], v[128:131], v[144:147], v[32:35]
    v_mfma_f32_16x16x32_bf16 v[44:47], v[136:139], v[148:151], v[44:47]
    v_mfma_f32_16x16x32_bf16 v[28:31], v[124:127], v[144:147], v[28:31]
    s_nop 0
    ds_write_b128 v176, v[20:23] offset:0
    v_mfma_f32_16x16x32_bf16 v[44:47], v[132:135], v[152:155], v[44:47]
    v_mfma_f32_16x16x32_bf16 v[32:35], v[124:127], v[148:151], v[32:35]
    ds_write_b128 v176, v[24:27] offset:1024
    v_mfma_f32_16x16x32_bf16 v[44:47], v[128:131], v[156:159], v[44:47]
    v_mfma_f32_16x16x32_bf16 v[28:31], v[120:123], v[148:151], v[28:31]
    ds_write_b128 v176, v[36:39] offset:2048
    v_mfma_f32_16x16x32_bf16 v[44:47], v[124:127], v[160:163], v[44:47]
    v_mfma_f32_16x16x32_bf16 v[32:35], v[120:123], v[152:155], v[32:35]
    ds_write_b128 v176, v[40:43] offset:3072
    v_mfma_f32_16x16x32_bf16 v[44:47], v[120:123], v[164:167], v[44:47]
    v_mfma_f32_16x16x32_bf16 v[28:31], v[116:119], v[152:155], v[28:31]
    ds_write_b32 v178, v180
    v_mfma_f32_16x16x32_bf16 v[32:35], v[116:119], v[156:159], v[32:35]
    v_mfma_f32_16x16x32_bf16 v[44:47], v[116:119], v[168:171], v[44:47]
    v_mfma_f32_16x16x32_bf16 v[16:19], v[112:115], v[144:147], v[16:19]
    v_mfma_f32_16x16x32_bf16 v[28:31], v[112:115], v[156:159], v[28:31]
    v_mfma_f32_16x16x32_bf16 v[32:35], v[112:115], v[160:163], v[32:35]
    v_mfma_f32_16x16x32_bf16 v[44:47], v[112:115], v[172:175], v[44:47]
cp13:
    ds_read_b32 v181, v179
    ds_read_b128 v[224:227], v177
    ds_read_b128 v[228:231], v177 offset:1024
    ds_read_b128 v[232:235], v177 offset:2048
    ds_read_b128 v[236:239], v177 offset:3072
    s_waitcnt lgkmcnt(0)
    v_readfirstlane_b32 s23, v181
    s_cmp_lg_u32 s23, 0
    s_cbranch_scc1 cpok13
    s_sub_u32 s101, s101, 1
    s_cmp_lt_i32 s101, 0
    s_cbranch_scc0 cp13
cpok13:
    v_pk_add_f32 v[16:17], v[16:17], v[224:225]
    v_pk_add_f32 v[18:19], v[18:19], v[226:227]
    v_pk_add_f32 v[28:29], v[28:29], v[228:229]
    v_pk_add_f32 v[30:31], v[30:31], v[230:231]
    v_pk_add_f32 v[32:33], v[32:33], v[232:233]
    v_pk_add_f32 v[34:35], v[34:35], v[234:235]
    v_pk_add_f32 v[44:45], v[44:45], v[236:237]
    v_pk_add_f32 v[46:47], v[46:47], v[238:239]
    v_cvt_pk_bf16_f32 v48, v16, v17
    v_cvt_pk_bf16_f32 v49, v18, v19
    v_cvt_pk_bf16_f32 v50, v28, v29
    v_cvt_pk_bf16_f32 v51, v30, v31
    v_cvt_pk_bf16_f32 v52, v32, v33
    v_cvt_pk_bf16_f32 v53, v34, v35
    v_cvt_pk_bf16_f32 v54, v44, v45
    v_cvt_pk_bf16_f32 v55, v46, v47
    s_branch cvend12
cv1_12:
    v_mfma_f32_16x16x32_bf16 v[44:47], v[140:143], v[144:147], v[44:47]
    v_mfma_f32_16x16x32_bf16 v[32:35], v[128:131], v[144:147], v[32:35]
    v_mfma_f32_16x16x32_bf16 v[44:47], v[136:139], v[148:151], v[44:47]
    v_mfma_f32_16x16x32_bf16 v[28:31], v[124:127], v[144:147], v[28:31]
    v_mfma_f32_16x16x32_bf16 v[44:47], v[132:135], v[152:155], v[44:47]
    v_mfma_f32_16x16x32_bf16 v[32:35], v[124:127], v[148:151], v[32:35]
    v_mfma_f32_16x16x32_bf16 v[44:47], v[128:131], v[156:159], v[44:47]
    v_fmac_f32 v20, v192, v220
    v_fmac_f32 v21, v193, v220
    v_mfma_f32_16x16x32_bf16 v[28:31], v[120:123], v[148:151], v[28:31]
    v_fmac_f32 v22, v194, v220
    v_fmac_f32 v23, v195, v220
    v_mfma_f32_16x16x32_bf16 v[44:47], v[124:127], v[160:163], v[44:47]
    v_fmac_f32 v24, v196, v220
    v_fmac_f32 v25, v197, v220
    v_mfma_f32_16x16x32_bf16 v[32:35], v[120:123], v[152:155], v[32:35]
    v_fmac_f32 v26, v198, v220
    v_fmac_f32 v27, v199, v220
    v_mfma_f32_16x16x32_bf16 v[44:47], v[120:123], v[164:167], v[44:47]
    v_fmac_f32 v36, v200, v220
    v_fmac_f32 v37, v201, v220
    v_mfma_f32_16x16x32_bf16 v[28:31], v[116:119], v[152:155], v[28:31]
    v_fmac_f32 v38, v202, v220
    v_fmac_f32 v39, v203, v220
    v_mfma_f32_16x16x32_bf16 v[32:35], v[116:119], v[156:159], v[32:35]
    v_fmac_f32 v40, v204, v220
    v_fmac_f32 v41, v205, v220
    v_mfma_f32_16x16x32_bf16 v[44:47], v[116:119], v[168:171], v[44:47]
    v_fmac_f32 v42, v206, v220
    v_fmac_f32 v43, v207, v220
    v_mfma_f32_16x16x32_bf16 v[16:19], v[112:115], v[144:147], v[16:19]
    v_mfma_f32_16x16x32_bf16 v[28:31], v[112:115], v[156:159], v[28:31]
    v_mfma_f32_16x16x32_bf16 v[32:35], v[112:115], v[160:163], v[32:35]
    v_mfma_f32_16x16x32_bf16 v[44:47], v[112:115], v[172:175], v[44:47]
    v_mfma_f32_16x16x32_bf16 v[40:43], v[136:139], v[144:147], v[40:43]
    v_mfma_f32_16x16x32_bf16 v[36:39], v[132:135], v[144:147], v[36:39]
    v_mfma_f32_16x16x32_bf16 v[40:43], v[132:135], v[148:151], v[40:43]
    v_mfma_f32_16x16x32_bf16 v[36:39], v[128:131], v[148:151], v[36:39]
    s_nop 0
    ds_write_b128 v176, v[16:19] offset:0
    v_mfma_f32_16x16x32_bf16 v[40:43], v[128:131], v[152:155], v[40:43]
    v_mfma_f32_16x16x32_bf16 v[36:39], v[124:127], v[152:155], v[36:39]
    ds_write_b128 v176, v[28:31] offset:1024
    v_mfma_f32_16x16x32_bf16 v[40:43], v[124:127], v[156:159], v[40:43]
    v_mfma_f32_16x16x32_bf16 v[24:27], v[120:123], v[144:147], v[24:27]
    ds_write_b128 v176, v[32:35] offset:2048
    v_mfma_f32_16x16x32_bf16 v[36:39], v[120:123], v[156:159], v[36:39]
    v_mfma_f32_16x16x32_bf16 v[40:43], v[120:123], v[160:163], v[40:43]
    ds_write_b128 v176, v[44:47] offset:3072
    v_mfma_f32_16x16x32_bf16 v[20:23], v[116:119], v[144:147], v[20:23]
    v_mfma_f32_16x16x32_bf16 v[24:27], v[116:119], v[148:151], v[24:27]
    ds_write_b32 v178, v180
    v_mfma_f32_16x16x32_bf16 v[36:39], v[116:119], v[160:163], v[36:39]
    v_mfma_f32_16x16x32_bf16 v[40:43], v[116:119], v[164:167], v[40:43]
    v_mfma_f32_16x16x32_bf16 v[20:23], v[112:115], v[148:151], v[20:23]
    v_mfma_f32_16x16x32_bf16 v[24:27], v[112:115], v[152:155], v[24:27]
    v_mfma_f32_16x16x32_bf16 v[36:39], v[112:115], v[164:167], v[36:39]
    v_mfma_f32_16x16x32_bf16 v[40:43], v[112:115], v[168:171], v[40:43]
cp14:
    ds_read_b32 v181, v179
    ds_read_b128 v[224:227], v177
    ds_read_b128 v[228:231], v177 offset:1024
    ds_read_b128 v[232:235], v177 offset:2048
    ds_read_b128 v[236:239], v177 offset:3072
    s_waitcnt lgkmcnt(0)
    v_readfirstlane_b32 s23, v181
    s_cmp_lg_u32 s23, 0
    s_cbranch_scc1 cpok14
    s_sub_u32 s101, s101, 1
    s_cmp_lt_i32 s101, 0
    s_cbranch_scc0 cp14
cpok14:
    v_pk_add_f32 v[20:21], v[20:21], v[224:225]
    v_pk_add_f32 v[22:23], v[22:23], v[226:227]
    v_pk_add_f32 v[24:25], v[24:25], v[228:229]
    v_pk_add_f32 v[26:27], v[26:27], v[230:231]
    v_pk_add_f32 v[36:37], v[36:37], v[232:233]
    v_pk_add_f32 v[38:39], v[38:39], v[234:235]
    v_pk_add_f32 v[40:41], v[40:41], v[236:237]
    v_pk_add_f32 v[42:43], v[42:43], v[238:239]
    v_cvt_pk_bf16_f32 v48, v20, v21
    v_cvt_pk_bf16_f32 v49, v22, v23
    v_cvt_pk_bf16_f32 v50, v24, v25
    v_cvt_pk_bf16_f32 v51, v26, v27
    v_cvt_pk_bf16_f32 v52, v36, v37
    v_cvt_pk_bf16_f32 v53, v38, v39
    v_cvt_pk_bf16_f32 v54, v40, v41
    v_cvt_pk_bf16_f32 v55, v42, v43
cvend12:
    v_permlane16_swap_b32 v48, v50
    v_permlane16_swap_b32 v49, v51
    v_permlane16_swap_b32 v52, v54
    v_permlane16_swap_b32 v53, v55
    buffer_store_dwordx4 v[48:51], v15, s[4:7], s26 offen offset:0 sc1
    buffer_store_dwordx4 v[52:55], v15, s[4:7], s26 offen offset:2048 sc1
    s_waitcnt vmcnt(0)
    s_lshr_b32 s22, s66, 5
    s_lshl_b32 s22, s22, 1
    s_add_u32 s22, s22, s21
    s_lshl_b32 s22, s22, 5
    s_and_b32 s23, s66, 31
    s_add_u32 s22, s22, s23
    s_lshl_b32 s22, s22, 1
    s_add_u32 s22, s22, s20
    s_lshl_b32 s22, s22, 3
    s_add_u32 s22, s22, 196736
    v_mov_b32 v10, s30
    v_mov_b32 v11, s31
    v_mov_b32 v12, 0
    s_mov_b64 exec, 1
    buffer_store_dwordx2 v[10:11], v12, s[12:15], s22 offen sc1
    s_mov_b64 exec, -1
    s_endpgm
A_helper:
    s_mov_b32 s4, s32
    s_mov_b32 s5, s33
    s_mov_b32 s6, 0x200000
    s_mov_b32 s7, 0x20000
    s_mov_b32 s8, s48
    s_mov_b32 s9, s49
    s_mov_b32 s10, 0x158000
    s_mov_b32 s11, 0x20000
    s_mov_b32 s12, s50
    s_mov_b32 s13, s51
    s_mov_b32 s14, 0x158000
    s_mov_b32 s15, 0x20000
    v_mov_b32 v2, 34048
    v_mov_b32 v4, 0
    v_mov_b32 v5, 0
    ds_write_b64 v2, v[4:5] offset:0
    ds_write_b64 v2, v[4:5] offset:8
    ds_write_b64 v2, v[4:5] offset:16
    ds_write_b64 v2, v[4:5] offset:24
    ds_write_b64 v2, v[4:5] offset:40
    ds_write_b64 v2, v[4:5] offset:48
    ds_write_b64 v2, v[4:5] offset:56
    s_lshl_b32 s26, s77, 1
    v_lshrrev_b32 v2, 3, v1
    v_and_b32 v3, 7, v1
    v_lshrrev_b32 v4, 4, v1
    s_lshl_b32 s68, s64, 7
    s_lshl_b32 s69, s26, 5
    s_add_u32 s68, s68, s69
    v_add_u32 v2, s68, v2
    v_lshlrev_b32 v2, 10, v2
    v_xor_b32 v5, v4, v3
    v_lshl_add_u32 v236, v5, 4, v2
    v_xor_b32 v237, 64, v236
    v_add_u32 v237, 8192, v237
    v_add_u32 v238, 16384, v236
    v_add_u32 v239, 16384, v237
    s_lshl_b32 s72, s26, 12
    s_mul_i32 s68, s26, 192
    s_mul_i32 s69, s65, 192
    s_mov_b32 s70, 43691
    v_add_u32 v2, s68, v1
    v_add_u32 v5, 0, v2
    v_mul_u32_u24 v6, s70, v5
    v_lshrrev_b32 v6, 19, v6
    v_mul_u32_u24 v6, 2560, v6
    v_lshl_add_u32 v6, v5, 4, v6
    v_add_u32 v240, s69, v6
    v_add_u32 v5, 64, v2
    v_mul_u32_u24 v6, s70, v5
    v_lshrrev_b32 v6, 19, v6
    v_mul_u32_u24 v6, 2560, v6
    v_lshl_add_u32 v6, v5, 4, v6
    v_add_u32 v241, s69, v6
    v_add_u32 v5, 128, v2
    v_mul_u32_u24 v6, s70, v5
    v_lshrrev_b32 v6, 19, v6
    v_mul_u32_u24 v6, 2560, v6
    v_lshl_add_u32 v6, v5, 4, v6
    v_add_u32 v242, s69, v6
    s_cmp_ge_u32 s65, 14
    s_cbranch_scc1 mask17
nomask17:
    s_mul_i32 s73, s26, 3072
    s_add_u32 s73, s73, 16384
    s_add_u32 s26, s26, 1
    v_lshrrev_b32 v2, 3, v1
    v_and_b32 v3, 7, v1
    v_lshrrev_b32 v4, 4, v1
    s_lshl_b32 s68, s64, 7
    s_lshl_b32 s69, s26, 5
    s_add_u32 s68, s68, s69
    v_add_u32 v2, s68, v2
    v_lshlrev_b32 v2, 10, v2
    v_xor_b32 v5, v4, v3
    v_lshl_add_u32 v244, v5, 4, v2
    v_xor_b32 v245, 64, v244
    v_add_u32 v245, 8192, v245
    v_add_u32 v246, 16384, v244
    v_add_u32 v247, 16384, v245
    s_lshl_b32 s16, s26, 12
    s_mul_i32 s68, s26, 192
    s_mul_i32 s69, s65, 192
    s_mov_b32 s70, 43691
    v_add_u32 v2, s68, v1
    v_add_u32 v5, 0, v2
    v_mul_u32_u24 v6, s70, v5
    v_lshrrev_b32 v6, 19, v6
    v_mul_u32_u24 v6, 2560, v6
    v_lshl_add_u32 v6, v5, 4, v6
    v_add_u32 v248, s69, v6
    v_add_u32 v5, 64, v2
    v_mul_u32_u24 v6, s70, v5
    v_lshrrev_b32 v6, 19, v6
    v_mul_u32_u24 v6, 2560, v6
    v_lshl_add_u32 v6, v5, 4, v6
    v_add_u32 v249, s69, v6
    v_add_u32 v5, 128, v2
    v_mul_u32_u24 v6, s70, v5
    v_lshrrev_b32 v6, 19, v6
    v_mul_u32_u24 v6, 2560, v6
    v_lshl_add_u32 v6, v5, 4, v6
    v_add_u32 v250, s69, v6
    s_cmp_ge_u32 s65, 14
    s_cbranch_scc1 mask18
nomask18:
    s_mul_i32 s17, s26, 3072
    s_add_u32 s17, s17, 16384
    s_mul_i32 s23, s77, 4352
    v_and_b32 v5, 15, v1
    v_lshrrev_b32 v6, 4, v1
    v_mul_u32_u24 v3, 272, v5
    v_lshl_add_u32 v3, v6, 4, v3
    v_add_u32 v3, s23, v3
    s_mov_b32 s22, 0x3fb8aa3b
    v_lshrrev_b32 v7, 1, v6
    v_lshlrev_b32 v4, 9, v7
    v_lshl_add_u32 v4, v5, 5, v4
    v_and_b32 v16, 1, v6
    v_lshl_add_u32 v4, v16, 4, v4
    v_add_u32 v4, s23, v4
    v_lshlrev_b32 v16, 8, v6
    v_sub_u32 v17, 4, v7
    v_lshlrev_b32 v17, v17, v5
    v_add3_u32 v17, v17, v16, s23
    v_mul_u32_u24 v18, 120, v7
    v_add3_u32 v18, v18, v17, 8
    v_lshl_add_u32 v19, v5, 2, v16
    v_add_u32 v19, s23, v19
    s_mov_b32 m0, s23
    s_waitcnt vmcnt(0)
    v_lshlrev_b32 v10, 16, v10
    v_lshlrev_b32 v11, 16, v11
    v_lshlrev_b32 v12, 16, v12
    v_lshlrev_b32 v13, 16, v13
    v_lshlrev_b32 v14, 16, v14
    v_mul_f32 v36, 0x3fb8aa3b, v14
    v_fma_f32 v37, v14, s22, -v36
    v_fmac_f32 v37, 0x32a57060, v14
    v_exp_f32 v36, v36
    v_mul_f32 v37, 0x3f317218, v37
    v_fmac_f32 v36, v36, v37
    v_cvt_pk_bf16_f32 v36, v36, v36
    v_and_b32 v14, 0xffff0000, v36
    v_mul_f32 v38, 0x3fb8aa3b, v10
    v_fma_f32 v39, v10, s22, -v38
    v_fmac_f32 v39, 0x32a57060, v10
    v_exp_f32 v38, v38
    v_mul_f32 v39, 0x3f317218, v39
    v_fmac_f32 v38, v38, v39
    v_cvt_pk_bf16_f32 v38, v38, v38
    v_and_b32 v10, 0xffff0000, v38
    v_mul_f32 v10, v10, v14
    v_mul_f32 v11, v11, v14
    v_add_f32 v14, v14, v14
    v_mul_f32 v10, 0xbfb8aa3b, v10
    v_mul_f32 v11, 0.15915494, v11
    v_mul_f32 v80, v12, v14
    v_mul_f32 v81, v13, v14
    v_mov_b32 v36, v10
    v_fract_f32 v37, v11
    v_mul_f32 v38, 0x41000000, v10
    v_mul_f32 v39, 0x41000000, v11
    v_mul_f32 v40, 0x43000000, v10
    v_mul_f32 v41, 0x43000000, v11
    v_fract_f32 v39, v39
    v_fract_f32 v41, v41
    v_exp_f32 v36, v36
    v_cos_f32 v20, v37
    v_sin_f32 v21, v37
    v_exp_f32 v38, v38
    v_cos_f32 v22, v39
    v_sin_f32 v23, v39
    v_exp_f32 v40, v40
    v_cos_f32 v24, v41
    v_sin_f32 v25, v41
    v_pk_mul_f32 v[20:21], v[20:21], v[36:37] op_sel:[0,0] op_sel_hi:[1,0]
    v_pk_mul_f32 v[22:23], v[22:23], v[38:39] op_sel:[0,0] op_sel_hi:[1,0]
    v_pk_mul_f32 v[24:25], v[24:25], v[40:41] op_sel:[0,0] op_sel_hi:[1,0]
    v_mov_b32 v48, 1.0
    v_mov_b32 v49, 0
    v_mov_b32 v50, v22
    v_mov_b32 v51, v23
    v_pk_mul_f32 v[52:53], v[50:51], v[50:51] op_sel:[0,0] op_sel_hi:[1,0]
    v_pk_mul_f32 v[32:33], v[20:21], v[20:21] op_sel:[0,0] op_sel_hi:[1,0]
    v_pk_mul_f32 v[82:83], v[80:81], v[20:21] op_sel:[0,0] op_sel_hi:[1,0]
    v_pk_mul_f32 v[26:27], v[24:25], v[24:25] op_sel:[0,0] op_sel_hi:[1,0]
    v_pk_fma_f32 v[52:53], v[50:51], v[50:51], v[52:53] op_sel:[1,1,0] op_sel_hi:[0,1,1] neg_lo:[1,0,0]
    v_pk_fma_f32 v[32:33], v[20:21], v[20:21], v[32:33] op_sel:[1,1,0] op_sel_hi:[0,1,1] neg_lo:[1,0,0]
    v_pk_fma_f32 v[82:83], v[80:81], v[20:21], v[82:83] op_sel:[1,1,0] op_sel_hi:[0,1,1] neg_lo:[1,0,0]
    v_pk_fma_f32 v[26:27], v[24:25], v[24:25], v[26:27] op_sel:[1,1,0] op_sel_hi:[0,1,1] neg_lo:[1,0,0]
    v_pk_mul_f32 v[54:55], v[52:53], v[50:51] op_sel:[0,0] op_sel_hi:[1,0]
    v_pk_mul_f32 v[56:57], v[52:53], v[52:53] op_sel:[0,0] op_sel_hi:[1,0]
    v_pk_mul_f32 v[34:35], v[32:33], v[32:33] op_sel:[0,0] op_sel_hi:[1,0]
    v_pk_mul_f32 v[84:85], v[80:81], v[32:33] op_sel:[0,0] op_sel_hi:[1,0]
    v_pk_mul_f32 v[86:87], v[82:83], v[32:33] op_sel:[0,0] op_sel_hi:[1,0]
    v_pk_mul_f32 v[28:29], v[26:27], v[26:27] op_sel:[0,0] op_sel_hi:[1,0]
    v_pk_fma_f32 v[54:55], v[52:53], v[50:51], v[54:55] op_sel:[1,1,0] op_sel_hi:[0,1,1] neg_lo:[1,0,0]
    v_pk_fma_f32 v[56:57], v[52:53], v[52:53], v[56:57] op_sel:[1,1,0] op_sel_hi:[0,1,1] neg_lo:[1,0,0]
    v_pk_fma_f32 v[34:35], v[32:33], v[32:33], v[34:35] op_sel:[1,1,0] op_sel_hi:[0,1,1] neg_lo:[1,0,0]
    v_pk_fma_f32 v[84:85], v[80:81], v[32:33], v[84:85] op_sel:[1,1,0] op_sel_hi:[0,1,1] neg_lo:[1,0,0]
    v_pk_fma_f32 v[86:87], v[82:83], v[32:33], v[86:87] op_sel:[1,1,0] op_sel_hi:[0,1,1] neg_lo:[1,0,0]
    v_pk_fma_f32 v[28:29], v[26:27], v[26:27], v[28:29] op_sel:[1,1,0] op_sel_hi:[0,1,1] neg_lo:[1,0,0]
    v_pk_mul_f32 v[58:59], v[56:57], v[50:51] op_sel:[0,0] op_sel_hi:[1,0]
    v_pk_mul_f32 v[60:61], v[56:57], v[52:53] op_sel:[0,0] op_sel_hi:[1,0]
    v_pk_mul_f32 v[62:63], v[56:57], v[54:55] op_sel:[0,0] op_sel_hi:[1,0]
    v_pk_mul_f32 v[64:65], v[56:57], v[56:57] op_sel:[0,0] op_sel_hi:[1,0]
    v_pk_mul_f32 v[88:89], v[80:81], v[34:35] op_sel:[0,0] op_sel_hi:[1,0]
    v_pk_mul_f32 v[90:91], v[82:83], v[34:35] op_sel:[0,0] op_sel_hi:[1,0]
    v_pk_mul_f32 v[92:93], v[84:85], v[34:35] op_sel:[0,0] op_sel_hi:[1,0]
    v_pk_mul_f32 v[94:95], v[86:87], v[34:35] op_sel:[0,0] op_sel_hi:[1,0]
    v_pk_mul_f32 v[30:31], v[28:29], v[28:29] op_sel:[0,0] op_sel_hi:[1,0]
    v_pk_fma_f32 v[58:59], v[56:57], v[50:51], v[58:59] op_sel:[1,1,0] op_sel_hi:[0,1,1] neg_lo:[1,0,0]
    v_pk_fma_f32 v[60:61], v[56:57], v[52:53], v[60:61] op_sel:[1,1,0] op_sel_hi:[0,1,1] neg_lo:[1,0,0]
    v_pk_fma_f32 v[62:63], v[56:57], v[54:55], v[62:63] op_sel:[1,1,0] op_sel_hi:[0,1,1] neg_lo:[1,0,0]
    v_pk_fma_f32 v[64:65], v[56:57], v[56:57], v[64:65] op_sel:[1,1,0] op_sel_hi:[0,1,1] neg_lo:[1,0,0]
    v_pk_fma_f32 v[88:89], v[80:81], v[34:35], v[88:89] op_sel:[1,1,0] op_sel_hi:[0,1,1] neg_lo:[1,0,0]
    v_pk_fma_f32 v[90:91], v[82:83], v[34:35], v[90:91] op_sel:[1,1,0] op_sel_hi:[0,1,1] neg_lo:[1,0,0]
    v_pk_fma_f32 v[92:93], v[84:85], v[34:35], v[92:93] op_sel:[1,1,0] op_sel_hi:[0,1,1] neg_lo:[1,0,0]
    v_pk_fma_f32 v[94:95], v[86:87], v[34:35], v[94:95] op_sel:[1,1,0] op_sel_hi:[0,1,1] neg_lo:[1,0,0]
    v_pk_fma_f32 v[30:31], v[28:29], v[28:29], v[30:31] op_sel:[1,1,0] op_sel_hi:[0,1,1] neg_lo:[1,0,0]
    v_pk_mul_f32 v[66:67], v[64:65], v[50:51] op_sel:[0,0] op_sel_hi:[1,0]
    v_pk_mul_f32 v[68:69], v[64:65], v[52:53] op_sel:[0,0] op_sel_hi:[1,0]
    v_pk_mul_f32 v[70:71], v[64:65], v[54:55] op_sel:[0,0] op_sel_hi:[1,0]
    v_pk_mul_f32 v[72:73], v[64:65], v[56:57] op_sel:[0,0] op_sel_hi:[1,0]
    v_pk_mul_f32 v[74:75], v[64:65], v[58:59] op_sel:[0,0] op_sel_hi:[1,0]
    v_pk_mul_f32 v[76:77], v[64:65], v[60:61] op_sel:[0,0] op_sel_hi:[1,0]
    v_pk_mul_f32 v[78:79], v[64:65], v[62:63] op_sel:[0,0] op_sel_hi:[1,0]
    v_pk_fma_f32 v[66:67], v[64:65], v[50:51], v[66:67] op_sel:[1,1,0] op_sel_hi:[0,1,1] neg_lo:[1,0,0]
    v_pk_fma_f32 v[68:69], v[64:65], v[52:53], v[68:69] op_sel:[1,1,0] op_sel_hi:[0,1,1] neg_lo:[1,0,0]
    v_pk_fma_f32 v[70:71], v[64:65], v[54:55], v[70:71] op_sel:[1,1,0] op_sel_hi:[0,1,1] neg_lo:[1,0,0]
    v_pk_fma_f32 v[72:73], v[64:65], v[56:57], v[72:73] op_sel:[1,1,0] op_sel_hi:[0,1,1] neg_lo:[1,0,0]
    v_pk_fma_f32 v[74:75], v[64:65], v[58:59], v[74:75] op_sel:[1,1,0] op_sel_hi:[0,1,1] neg_lo:[1,0,0]
    v_pk_fma_f32 v[76:77], v[64:65], v[60:61], v[76:77] op_sel:[1,1,0] op_sel_hi:[0,1,1] neg_lo:[1,0,0]
    v_pk_fma_f32 v[78:79], v[64:65], v[62:63], v[78:79] op_sel:[1,1,0] op_sel_hi:[0,1,1] neg_lo:[1,0,0]
    v_cvt_pk_bf16_f32 v170, v48, -v49
    v_cvt_pk_bf16_f32 v171, v50, -v51
    v_cvt_pk_bf16_f32 v172, v52, -v53
    v_cvt_pk_bf16_f32 v173, v54, -v55
    v_cvt_pk_bf16_f32 v174, v56, -v57
    v_cvt_pk_bf16_f32 v175, v58, -v59
    v_cvt_pk_bf16_f32 v176, v60, -v61
    v_cvt_pk_bf16_f32 v177, v62, -v63
    v_cvt_pk_bf16_f32 v178, v64, -v65
    v_cvt_pk_bf16_f32 v179, v66, -v67
    v_cvt_pk_bf16_f32 v180, v68, -v69
    v_cvt_pk_bf16_f32 v181, v70, -v71
    v_cvt_pk_bf16_f32 v182, v72, -v73
    v_cvt_pk_bf16_f32 v183, v74, -v75
    v_cvt_pk_bf16_f32 v184, v76, -v77
    v_cvt_pk_bf16_f32 v185, v78, -v79
    ds_write_addtid_b32 v170 offset:0
    ds_write_addtid_b32 v171 offset:272
    ds_write_addtid_b32 v172 offset:544
    ds_write_addtid_b32 v173 offset:816
    ds_write_addtid_b32 v174 offset:1088
    ds_write_addtid_b32 v175 offset:1360
    ds_write_addtid_b32 v176 offset:1632
    ds_write_addtid_b32 v177 offset:1904
    ds_write_addtid_b32 v178 offset:2176
    ds_write_addtid_b32 v179 offset:2448
    ds_write_addtid_b32 v180 offset:2720
    ds_write_addtid_b32 v181 offset:2992
    ds_write_addtid_b32 v182 offset:3264
    ds_write_addtid_b32 v183 offset:3536
    ds_write_addtid_b32 v184 offset:3808
    ds_write_addtid_b32 v185 offset:4080
    ds_read_b128 v[192:195], v3 offset:0
    ds_read_b128 v[196:199], v3 offset:64
    ds_read_b128 v[200:203], v3 offset:128
    ds_read_b128 v[204:207], v3 offset:192
    v_pk_mul_f32 v[96:97], v[80:81], v[24:25] op_sel:[0,0] op_sel_hi:[1,0]
    v_pk_mul_f32 v[98:99], v[82:83], v[24:25] op_sel:[0,0] op_sel_hi:[1,0]
    v_pk_mul_f32 v[100:101], v[84:85], v[24:25] op_sel:[0,0] op_sel_hi:[1,0]
    v_pk_mul_f32 v[102:103], v[86:87], v[24:25] op_sel:[0,0] op_sel_hi:[1,0]
    v_pk_mul_f32 v[104:105], v[88:89], v[24:25] op_sel:[0,0] op_sel_hi:[1,0]
    v_pk_mul_f32 v[106:107], v[90:91], v[24:25] op_sel:[0,0] op_sel_hi:[1,0]
    v_pk_mul_f32 v[108:109], v[92:93], v[24:25] op_sel:[0,0] op_sel_hi:[1,0]
    v_pk_mul_f32 v[110:111], v[94:95], v[24:25] op_sel:[0,0] op_sel_hi:[1,0]
    v_pk_fma_f32 v[96:97], v[80:81], v[24:25], v[96:97] op_sel:[1,1,0] op_sel_hi:[0,1,1] neg_lo:[1,0,0]
    v_pk_fma_f32 v[98:99], v[82:83], v[24:25], v[98:99] op_sel:[1,1,0] op_sel_hi:[0,1,1] neg_lo:[1,0,0]
    v_pk_fma_f32 v[100:101], v[84:85], v[24:25], v[100:101] op_sel:[1,1,0] op_sel_hi:[0,1,1] neg_lo:[1,0,0]
    v_pk_fma_f32 v[102:103], v[86:87], v[24:25], v[102:103] op_sel:[1,1,0] op_sel_hi:[0,1,1] neg_lo:[1,0,0]
    v_pk_fma_f32 v[104:105], v[88:89], v[24:25], v[104:105] op_sel:[1,1,0] op_sel_hi:[0,1,1] neg_lo:[1,0,0]
    v_pk_fma_f32 v[106:107], v[90:91], v[24:25], v[106:107] op_sel:[1,1,0] op_sel_hi:[0,1,1] neg_lo:[1,0,0]
    v_pk_fma_f32 v[108:109], v[92:93], v[24:25], v[108:109] op_sel:[1,1,0] op_sel_hi:[0,1,1] neg_lo:[1,0,0]
    v_pk_fma_f32 v[110:111], v[94:95], v[24:25], v[110:111] op_sel:[1,1,0] op_sel_hi:[0,1,1] neg_lo:[1,0,0]
    v_cvt_pk_bf16_f32 v170, v80, v81
    v_cvt_pk_bf16_f32 v171, v82, v83
    v_cvt_pk_bf16_f32 v172, v84, v85
    v_cvt_pk_bf16_f32 v173, v86, v87
    v_cvt_pk_bf16_f32 v174, v88, v89
    v_cvt_pk_bf16_f32 v175, v90, v91
    v_cvt_pk_bf16_f32 v176, v92, v93
    v_cvt_pk_bf16_f32 v177, v94, v95
    v_cvt_pk_bf16_f32 v178, v96, v97
    v_cvt_pk_bf16_f32 v179, v98, v99
    v_cvt_pk_bf16_f32 v180, v100, v101
    v_cvt_pk_bf16_f32 v181, v102, v103
    v_cvt_pk_bf16_f32 v182, v104, v105
    v_cvt_pk_bf16_f32 v183, v106, v107
    v_cvt_pk_bf16_f32 v184, v108, v109
    v_cvt_pk_bf16_f32 v185, v110, v111
    ds_write_addtid_b32 v170 offset:0
    ds_write_addtid_b32 v171 offset:272
    ds_write_addtid_b32 v172 offset:544
    ds_write_addtid_b32 v173 offset:816
    ds_write_addtid_b32 v174 offset:1088
    ds_write_addtid_b32 v175 offset:1360
    ds_write_addtid_b32 v176 offset:1632
    ds_write_addtid_b32 v177 offset:1904
    ds_write_addtid_b32 v178 offset:2176
    ds_write_addtid_b32 v179 offset:2448
    ds_write_addtid_b32 v180 offset:2720
    ds_write_addtid_b32 v181 offset:2992
    ds_write_addtid_b32 v182 offset:3264
    ds_write_addtid_b32 v183 offset:3536
    ds_write_addtid_b32 v184 offset:3808
    ds_write_addtid_b32 v185 offset:4080
    ds_read_b128 v[208:211], v3 offset:0
    ds_read_b128 v[212:215], v3 offset:64
    ds_read_b128 v[216:219], v3 offset:128
    ds_read_b128 v[220:223], v3 offset:192
    s_mov_b32 m0, s23
    v_pk_mul_f32 v[112:113], v[80:81], v[26:27] op_sel:[0,0] op_sel_hi:[1,0]
    v_pk_mul_f32 v[114:115], v[84:85], v[26:27] op_sel:[0,0] op_sel_hi:[1,0]
    v_pk_mul_f32 v[116:117], v[88:89], v[26:27] op_sel:[0,0] op_sel_hi:[1,0]
    v_pk_mul_f32 v[118:119], v[92:93], v[26:27] op_sel:[0,0] op_sel_hi:[1,0]
    v_pk_mul_f32 v[120:121], v[96:97], v[26:27] op_sel:[0,0] op_sel_hi:[1,0]
    v_pk_mul_f32 v[122:123], v[100:101], v[26:27] op_sel:[0,0] op_sel_hi:[1,0]
    v_pk_mul_f32 v[124:125], v[104:105], v[26:27] op_sel:[0,0] op_sel_hi:[1,0]
    v_pk_mul_f32 v[126:127], v[108:109], v[26:27] op_sel:[0,0] op_sel_hi:[1,0]
    v_pk_fma_f32 v[112:113], v[80:81], v[26:27], v[112:113] op_sel:[1,1,0] op_sel_hi:[0,1,1] neg_lo:[1,0,0]
    v_pk_fma_f32 v[114:115], v[84:85], v[26:27], v[114:115] op_sel:[1,1,0] op_sel_hi:[0,1,1] neg_lo:[1,0,0]
    v_pk_fma_f32 v[116:117], v[88:89], v[26:27], v[116:117] op_sel:[1,1,0] op_sel_hi:[0,1,1] neg_lo:[1,0,0]
    v_pk_fma_f32 v[118:119], v[92:93], v[26:27], v[118:119] op_sel:[1,1,0] op_sel_hi:[0,1,1] neg_lo:[1,0,0]
    v_pk_fma_f32 v[120:121], v[96:97], v[26:27], v[120:121] op_sel:[1,1,0] op_sel_hi:[0,1,1] neg_lo:[1,0,0]
    v_pk_fma_f32 v[122:123], v[100:101], v[26:27], v[122:123] op_sel:[1,1,0] op_sel_hi:[0,1,1] neg_lo:[1,0,0]
    v_pk_fma_f32 v[124:125], v[104:105], v[26:27], v[124:125] op_sel:[1,1,0] op_sel_hi:[0,1,1] neg_lo:[1,0,0]
    v_pk_fma_f32 v[126:127], v[108:109], v[26:27], v[126:127] op_sel:[1,1,0] op_sel_hi:[0,1,1] neg_lo:[1,0,0]
    v_pk_mul_f32 v[128:129], v[80:81], v[28:29] op_sel:[0,0] op_sel_hi:[1,0]
    v_pk_mul_f32 v[130:131], v[88:89], v[28:29] op_sel:[0,0] op_sel_hi:[1,0]
    v_pk_mul_f32 v[132:133], v[96:97], v[28:29] op_sel:[0,0] op_sel_hi:[1,0]
    v_pk_mul_f32 v[134:135], v[104:105], v[28:29] op_sel:[0,0] op_sel_hi:[1,0]
    v_pk_mul_f32 v[136:137], v[112:113], v[28:29] op_sel:[0,0] op_sel_hi:[1,0]
    v_pk_mul_f32 v[138:139], v[116:117], v[28:29] op_sel:[0,0] op_sel_hi:[1,0]
    v_pk_mul_f32 v[140:141], v[120:121], v[28:29] op_sel:[0,0] op_sel_hi:[1,0]
    v_pk_mul_f32 v[142:143], v[124:125], v[28:29] op_sel:[0,0] op_sel_hi:[1,0]
    v_pk_fma_f32 v[128:129], v[80:81], v[28:29], v[128:129] op_sel:[1,1,0] op_sel_hi:[0,1,1] neg_lo:[1,0,0]
    v_pk_fma_f32 v[130:131], v[88:89], v[28:29], v[130:131] op_sel:[1,1,0] op_sel_hi:[0,1,1] neg_lo:[1,0,0]
    v_pk_fma_f32 v[132:133], v[96:97], v[28:29], v[132:133] op_sel:[1,1,0] op_sel_hi:[0,1,1] neg_lo:[1,0,0]
    v_pk_fma_f32 v[134:135], v[104:105], v[28:29], v[134:135] op_sel:[1,1,0] op_sel_hi:[0,1,1] neg_lo:[1,0,0]
    v_pk_fma_f32 v[136:137], v[112:113], v[28:29], v[136:137] op_sel:[1,1,0] op_sel_hi:[0,1,1] neg_lo:[1,0,0]
    v_pk_fma_f32 v[138:139], v[116:117], v[28:29], v[138:139] op_sel:[1,1,0] op_sel_hi:[0,1,1] neg_lo:[1,0,0]
    v_pk_fma_f32 v[140:141], v[120:121], v[28:29], v[140:141] op_sel:[1,1,0] op_sel_hi:[0,1,1] neg_lo:[1,0,0]
    v_pk_fma_f32 v[142:143], v[124:125], v[28:29], v[142:143] op_sel:[1,1,0] op_sel_hi:[0,1,1] neg_lo:[1,0,0]
    s_waitcnt lgkmcnt(0)
    v_mfma_f32_16x16x32_bf16 v[224:227], v[208:211], v[192:195], 0
    v_mfma_f32_16x16x32_bf16 v[224:227], v[212:215], v[196:199], v[224:227]
    v_mfma_f32_16x16x32_bf16 v[224:227], v[216:219], v[200:203], v[224:227]
    v_mfma_f32_16x16x32_bf16 v[224:227], v[220:223], v[204:207], v[224:227]
    v_cvt_pk_bf16_f32 v170, v112, v113
    v_cvt_pk_bf16_f32 v171, v114, v115
    v_cvt_pk_bf16_f32 v172, v116, v117
    v_cvt_pk_bf16_f32 v173, v118, v119
    v_cvt_pk_bf16_f32 v174, v120, v121
    v_cvt_pk_bf16_f32 v175, v122, v123
    v_cvt_pk_bf16_f32 v176, v124, v125
    v_cvt_pk_bf16_f32 v177, v126, v127
    v_cvt_pk_bf16_f32 v178, v128, v129
    v_cvt_pk_bf16_f32 v179, v130, v131
    v_cvt_pk_bf16_f32 v180, v132, v133
    v_cvt_pk_bf16_f32 v181, v134, v135
    v_cvt_pk_bf16_f32 v182, v136, v137
    v_cvt_pk_bf16_f32 v183, v138, v139
    v_cvt_pk_bf16_f32 v184, v140, v141
    v_cvt_pk_bf16_f32 v185, v142, v143
    ds_write_addtid_b32 v170 offset:0
    ds_write_addtid_b32 v171 offset:272
    ds_write_addtid_b32 v172 offset:544
    ds_write_addtid_b32 v173 offset:816
    ds_write_addtid_b32 v174 offset:1088
    ds_write_addtid_b32 v175 offset:1360
    ds_write_addtid_b32 v176 offset:1632
    ds_write_addtid_b32 v177 offset:1904
    ds_write_addtid_b32 v178 offset:2176
    ds_write_addtid_b32 v179 offset:2448
    ds_write_addtid_b32 v180 offset:2720
    ds_write_addtid_b32 v181 offset:2992
    ds_write_addtid_b32 v182 offset:3264
    ds_write_addtid_b32 v183 offset:3536
    ds_write_addtid_b32 v184 offset:3808
    ds_write_addtid_b32 v185 offset:4080
    ds_read_b128 v[208:211], v3 offset:0
    ds_read_b128 v[212:215], v3 offset:64
    ds_read_b128 v[216:219], v3 offset:128
    ds_read_b128 v[220:223], v3 offset:192
    s_mov_b32 m0, s23
    v_pk_mul_f32 v[144:145], v[80:81], v[30:31] op_sel:[0,0] op_sel_hi:[1,0]
    v_pk_mul_f32 v[146:147], v[96:97], v[30:31] op_sel:[0,0] op_sel_hi:[1,0]
    v_pk_mul_f32 v[148:149], v[112:113], v[30:31] op_sel:[0,0] op_sel_hi:[1,0]
    v_pk_mul_f32 v[150:151], v[120:121], v[30:31] op_sel:[0,0] op_sel_hi:[1,0]
    v_pk_mul_f32 v[152:153], v[128:129], v[30:31] op_sel:[0,0] op_sel_hi:[1,0]
    v_pk_mul_f32 v[154:155], v[132:133], v[30:31] op_sel:[0,0] op_sel_hi:[1,0]
    v_pk_mul_f32 v[156:157], v[136:137], v[30:31] op_sel:[0,0] op_sel_hi:[1,0]
    v_pk_mul_f32 v[158:159], v[140:141], v[30:31] op_sel:[0,0] op_sel_hi:[1,0]
    v_pk_fma_f32 v[144:145], v[80:81], v[30:31], v[144:145] op_sel:[1,1,0] op_sel_hi:[0,1,1] neg_lo:[1,0,0]
    v_pk_fma_f32 v[146:147], v[96:97], v[30:31], v[146:147] op_sel:[1,1,0] op_sel_hi:[0,1,1] neg_lo:[1,0,0]
    v_pk_fma_f32 v[148:149], v[112:113], v[30:31], v[148:149] op_sel:[1,1,0] op_sel_hi:[0,1,1] neg_lo:[1,0,0]
    v_pk_fma_f32 v[150:151], v[120:121], v[30:31], v[150:151] op_sel:[1,1,0] op_sel_hi:[0,1,1] neg_lo:[1,0,0]
    v_pk_fma_f32 v[152:153], v[128:129], v[30:31], v[152:153] op_sel:[1,1,0] op_sel_hi:[0,1,1] neg_lo:[1,0,0]
    v_pk_fma_f32 v[154:155], v[132:133], v[30:31], v[154:155] op_sel:[1,1,0] op_sel_hi:[0,1,1] neg_lo:[1,0,0]
    v_pk_fma_f32 v[156:157], v[136:137], v[30:31], v[156:157] op_sel:[1,1,0] op_sel_hi:[0,1,1] neg_lo:[1,0,0]
    v_pk_fma_f32 v[158:159], v[140:141], v[30:31], v[158:159] op_sel:[1,1,0] op_sel_hi:[0,1,1] neg_lo:[1,0,0]
    v_pk_mul_f32 v[160:161], v[144:145], v[30:31] op_sel:[0,0] op_sel_hi:[1,0]
    v_pk_fma_f32 v[160:161], v[144:145], v[30:31], v[160:161] op_sel:[1,1,0] op_sel_hi:[0,1,1] neg_lo:[1,0,0]
    s_waitcnt lgkmcnt(0)
    v_mfma_f32_16x16x32_bf16 v[228:231], v[208:211], v[192:195], 0
    v_mfma_f32_16x16x32_bf16 v[228:231], v[212:215], v[196:199], v[228:231]
    v_mfma_f32_16x16x32_bf16 v[228:231], v[216:219], v[200:203], v[228:231]
    v_mfma_f32_16x16x32_bf16 v[228:231], v[220:223], v[204:207], v[228:231]
    v_cvt_pk_bf16_f32 v170, v144, v145
    v_cvt_pk_bf16_f32 v171, v146, v147
    v_cvt_pk_bf16_f32 v172, v148, v149
    v_cvt_pk_bf16_f32 v173, v150, v151
    v_cvt_pk_bf16_f32 v174, v152, v153
    v_cvt_pk_bf16_f32 v175, v154, v155
    v_cvt_pk_bf16_f32 v176, v156, v157
    v_cvt_pk_bf16_f32 v177, v158, v159
    v_cvt_pk_bf16_f32 v178, v160, v161
    ds_write_addtid_b32 v170 offset:0
    ds_write_addtid_b32 v171 offset:272
    ds_write_addtid_b32 v172 offset:544
    ds_write_addtid_b32 v173 offset:816
    ds_write_addtid_b32 v174 offset:1088
    ds_write_addtid_b32 v175 offset:1360
    ds_write_addtid_b32 v176 offset:1632
    ds_write_addtid_b32 v177 offset:1904
    ds_write_addtid_b32 v178 offset:2176
    ds_read_b128 v[208:211], v3 offset:0
    ds_read_b128 v[212:215], v3 offset:64
    ds_read_b128 v[216:219], v3 offset:128
    ds_read_b128 v[220:223], v3 offset:192
    s_waitcnt lgkmcnt(0)
    v_mfma_f32_16x16x32_bf16 v[232:235], v[208:211], v[192:195], 0
    v_mfma_f32_16x16x32_bf16 v[232:235], v[212:215], v[196:199], v[232:235]
    v_mfma_f32_16x16x32_bf16 v[232:235], v[216:219], v[200:203], v[232:235]
    v_mfma_f32_16x16x32_bf16 v[232:235], v[220:223], v[204:207], v[232:235]
    ds_write_b128 v4, v[224:227]
    ds_write_b64 v17, v[228:229] offset:1024
    ds_write_b64 v18, v[230:231] offset:1024
    s_nop 4
    ds_write_b32 v19, v232 offset:2048
    ds_write_b32 v19, v233 offset:2112
    ds_write_b32 v19, v234 offset:2176
    ds_write_b32 v19, v235 offset:2240
    s_waitcnt lgkmcnt(0)
    s_lshl_b32 s20, s77, 6
    v_add_u32 v180, s20, v1
    v_lshlrev_b32 v20, 3, v180
    v_mov_b32 v21, 127
    v_sub_u32 v184, 2047, v20
    v_sub_u32 v185, 2046, v20
    v_sub_u32 v186, 2045, v20
    v_sub_u32 v187, 2044, v20
    v_sub_u32 v188, 2043, v20
    v_sub_u32 v189, 2042, v20
    v_sub_u32 v190, 2041, v20
    v_sub_u32 v191, 2040, v20
    v_sub_u32 v192, 2039, v20
    v_cvt_f32_i32 v22, v184
    v_cvt_f32_i32 v23, v185
    v_cvt_f32_i32 v24, v186
    v_cvt_f32_i32 v25, v187
    v_cvt_f32_i32 v26, v188
    v_cvt_f32_i32 v27, v189
    v_cvt_f32_i32 v28, v190
    v_cvt_f32_i32 v29, v191
    v_cvt_f32_i32 v30, v192
    v_cvt_pk_bf16_f32 v22, v22, 0
    v_cvt_pk_bf16_f32 v23, v23, 0
    v_cvt_pk_bf16_f32 v24, v24, 0
    v_cvt_pk_bf16_f32 v25, v25, 0
    v_cvt_pk_bf16_f32 v26, v26, 0
    v_cvt_pk_bf16_f32 v27, v27, 0
    v_cvt_pk_bf16_f32 v28, v28, 0
    v_cvt_pk_bf16_f32 v29, v29, 0
    v_cvt_pk_bf16_f32 v30, v30, 0
    v_subrev_u32 v22, 17024, v22
    v_subrev_u32 v23, 17024, v23
    v_subrev_u32 v24, 17024, v24
    v_subrev_u32 v25, 17024, v25
    v_subrev_u32 v26, 17024, v26
    v_subrev_u32 v27, 17024, v27
    v_subrev_u32 v28, 17024, v28
    v_subrev_u32 v29, 17024, v29
    v_subrev_u32 v30, 17024, v30
    v_med3_i32 v184, v22, v184, v21
    v_med3_i32 v185, v23, v185, v21
    v_med3_i32 v186, v24, v186, v21
    v_med3_i32 v187, v25, v187, v21
    v_med3_i32 v188, v26, v188, v21
    v_med3_i32 v189, v27, v189, v21
    v_med3_i32 v190, v28, v190, v21
    v_med3_i32 v191, v29, v191, v21
    v_med3_i32 v192, v30, v192, v21
    v_lshlrev_b32 v184, 2, v184
    v_lshlrev_b32 v185, 2, v185
    v_lshlrev_b32 v186, 2, v186
    v_lshlrev_b32 v187, 2, v187
    v_lshlrev_b32 v188, 2, v188
    v_lshlrev_b32 v189, 2, v189
    v_lshlrev_b32 v190, 2, v190
    v_lshlrev_b32 v191, 2, v191
    v_lshlrev_b32 v192, 2, v192
    s_and_b32 s78, s62, 1
    s_lshl_b32 s78, s78, 2
    s_lshr_b32 s79, s62, 1
    s_add_u32 s78, s78, s79
    s_lshl_b32 s78, s78, 2
    s_lshr_b32 s79, s63, 3
    s_add_u32 s78, s78, s79
    s_and_b32 s79, s63, 7
    s_cmp_ge_u32 s77, 2
    s_cbranch_scc1 A_side
    s_mov_b32 s36, s60
    s_mov_b32 s37, s61
    s_mov_b32 s38, 0x560000
    s_mov_b32 s39, 0x20000
    s_mov_b32 s40, s52
    s_mov_b32 s41, s53
    s_mov_b32 s42, 0x158000
    s_mov_b32 s43, 0x20000
    v_lshlrev_b32 v6, 4, v1
    s_and_b32 s20, s77, 1
    s_lshl_b32 s21, s78, 1
    s_add_u32 s21, s21, s20
    s_mul_i32 s22, s21, 88064
    v_add_u32 v2, s22, v6
    s_xor_b32 s21, s21, 1
    s_mul_i32 s22, s21, 88064
    v_add_u32 v3, s22, v6
    s_mul_i32 s23, s77, 10240
    s_lshr_b32 s20, s77, 1
    s_add_u32 s23, s23, 117248
    v_lshrrev_b32 v7, 3, v1
    v_bfe_u32 v8, v1, 4, 1
    v_lshlrev_b32 v8, 2, v8
    v_and_b32 v4, 7, v1
    v_xor_b32 v4, v4, v8
    v_lshlrev_b32 v4, 4, v4
    v_lshl_add_u32 v4, v7, 10, v4
    s_lshl_b32 s21, s79, 7
    v_add_u32 v4, s21, v4
    v_lshrrev_b32 v7, 5, v1
    v_bfe_u32 v8, v1, 2, 2
    v_lshl_add_u32 v7, v7, 2, v8
    v_lshlrev_b32 v5, 7, v7
    v_bfe_u32 v7, v1, 3, 1
    v_xor_b32 v7, s20, v7
    v_lshl_add_u32 v5, v7, 6, v5
    v_and_b32 v7, 1, v1
    v_lshl_add_u32 v5, v7, 5, v5
    v_bfe_u32 v7, v1, 4, 1
    v_lshl_add_u32 v5, v7, 4, v5
    v_bfe_u32 v7, v1, 1, 1
    v_lshl_add_u32 v5, v7, 3, v5
    v_add_u32 v5, s23, v5
    v_xor_b32 v9, 64, v5
    s_lshr_b32 s25, s63, 3
    s_lshl_b32 s25, s25, 1
    s_add_u32 s24, s79, s25
    s_mul_i32 s24, s24, 11
    s_lshr_b32 s24, s24, 2
    s_cmp_ge_u32 s24, 22
    s_cselect_b32 s25, 22, 0
    s_sub_u32 s24, s24, s25
    s_lshl_b32 s24, s24, 2
    s_add_u32 s24, s24, s77
    s_lshl_b32 s24, s24, 10
    s_mov_b32 s25, s24
    s_lshl_b32 s26, s77, 10
    s_cmp_eq_u32 s65, 15
    s_cbranch_scc1 A_noload
    s_barrier
    s_add_u32 s74, s76, 2
    s_and_b32 s74, s74, 7
    s_mul_i32 s75, s74, 176128
    s_lshl_b32 s74, s74, 7
    s_add_u32 m0, s72, 117248
    s_nop 0
    buffer_load_dwordx4 v236, s[4:7], s74 offen lds
    s_add_u32 m0, s72, 118272
    s_nop 0
    buffer_load_dwordx4 v237, s[4:7], s74 offen lds
    s_add_u32 m0, s72, 119296
    s_nop 0
    buffer_load_dwordx4 v238, s[4:7], s74 offen lds
    s_add_u32 m0, s72, 120320
    s_nop 0
    buffer_load_dwordx4 v239, s[4:7], s74 offen lds
    s_add_u32 m0, s16, 117248
    s_nop 0
    buffer_load_dwordx4 v244, s[4:7], s74 offen lds
    s_add_u32 m0, s16, 118272
    s_nop 0
    buffer_load_dwordx4 v245, s[4:7], s74 offen lds
    s_add_u32 m0, s16, 119296
    s_nop 0
    buffer_load_dwordx4 v246, s[4:7], s74 offen lds
    s_add_u32 m0, s16, 120320
    s_nop 0
    buffer_load_dwordx4 v247, s[4:7], s74 offen lds
    s_add_u32 m0, s73, 117248
    s_nop 0
    buffer_load_dwordx4 v240, s[8:11], s75 offen lds
    s_add_u32 m0, s73, 129568
    s_nop 0
    buffer_load_dwordx4 v240, s[12:15], s75 offen lds
    s_add_u32 m0, s73, 118272
    s_nop 0
    buffer_load_dwordx4 v241, s[8:11], s75 offen lds
    s_add_u32 m0, s73, 130592
    s_nop 0
    buffer_load_dwordx4 v241, s[12:15], s75 offen lds
    s_add_u32 m0, s73, 119296
    s_nop 0
    buffer_load_dwordx4 v242, s[8:11], s75 offen lds
    s_add_u32 m0, s73, 131616
    s_nop 0
    buffer_load_dwordx4 v242, s[12:15], s75 offen lds
    s_add_u32 m0, s17, 117248
    s_nop 0
    buffer_load_dwordx4 v248, s[8:11], s75 offen lds
    s_add_u32 m0, s17, 129568
    s_nop 0
    buffer_load_dwordx4 v248, s[12:15], s75 offen lds
    s_add_u32 m0, s17, 118272
    s_nop 0
    buffer_load_dwordx4 v249, s[8:11], s75 offen lds
    s_add_u32 m0, s17, 130592
    s_nop 0
    buffer_load_dwordx4 v249, s[12:15], s75 offen lds
    s_add_u32 m0, s17, 119296
    s_nop 0
    buffer_load_dwordx4 v250, s[8:11], s75 offen lds
    s_add_u32 m0, s17, 131616
    s_nop 0
    buffer_load_dwordx4 v250, s[12:15], s75 offen lds
    s_barrier
    s_add_u32 s74, s76, 3
    s_and_b32 s74, s74, 7
    s_mul_i32 s75, s74, 176128
    s_lshl_b32 s74, s74, 7
    s_add_u32 m0, s72, 34816
    s_nop 0
    buffer_load_dwordx4 v236, s[4:7], s74 offen lds
    s_add_u32 m0, s72, 35840
    s_nop 0
    buffer_load_dwordx4 v237, s[4:7], s74 offen lds
    s_add_u32 m0, s72, 36864
    s_nop 0
    buffer_load_dwordx4 v238, s[4:7], s74 offen lds
    s_add_u32 m0, s72, 37888
    s_nop 0
    buffer_load_dwordx4 v239, s[4:7], s74 offen lds
    s_add_u32 m0, s16, 34816
    s_nop 0
    buffer_load_dwordx4 v244, s[4:7], s74 offen lds
    s_add_u32 m0, s16, 35840
    s_nop 0
    buffer_load_dwordx4 v245, s[4:7], s74 offen lds
    s_add_u32 m0, s16, 36864
    s_nop 0
    buffer_load_dwordx4 v246, s[4:7], s74 offen lds
    s_add_u32 m0, s16, 37888
    s_nop 0
    buffer_load_dwordx4 v247, s[4:7], s74 offen lds
    s_add_u32 m0, s73, 34816
    s_nop 0
    buffer_load_dwordx4 v240, s[8:11], s75 offen lds
    s_add_u32 m0, s73, 47136
    s_nop 0
    buffer_load_dwordx4 v240, s[12:15], s75 offen lds
    s_add_u32 m0, s73, 35840
    s_nop 0
    buffer_load_dwordx4 v241, s[8:11], s75 offen lds
    s_add_u32 m0, s73, 48160
    s_nop 0
    buffer_load_dwordx4 v241, s[12:15], s75 offen lds
    s_add_u32 m0, s73, 36864
    s_nop 0
    buffer_load_dwordx4 v242, s[8:11], s75 offen lds
    s_add_u32 m0, s73, 49184
    s_nop 0
    buffer_load_dwordx4 v242, s[12:15], s75 offen lds
    s_add_u32 m0, s17, 34816
    s_nop 0
    buffer_load_dwordx4 v248, s[8:11], s75 offen lds
    s_add_u32 m0, s17, 47136
    s_nop 0
    buffer_load_dwordx4 v248, s[12:15], s75 offen lds
    s_add_u32 m0, s17, 35840
    s_nop 0
    buffer_load_dwordx4 v249, s[8:11], s75 offen lds
    s_add_u32 m0, s17, 48160
    s_nop 0
    buffer_load_dwordx4 v249, s[12:15], s75 offen lds
    s_add_u32 m0, s17, 36864
    s_nop 0
    buffer_load_dwordx4 v250, s[8:11], s75 offen lds
    s_add_u32 m0, s17, 49184
    s_nop 0
    buffer_load_dwordx4 v250, s[12:15], s75 offen lds
    s_waitcnt vmcnt(20)
    s_barrier
    s_add_u32 s74, s76, 4
    s_and_b32 s74, s74, 7
    s_mul_i32 s75, s74, 176128
    s_lshl_b32 s74, s74, 7
    s_add_u32 m0, s72, 76032
    s_nop 0
    buffer_load_dwordx4 v236, s[4:7], s74 offen lds
    s_add_u32 m0, s72, 77056
    s_nop 0
    buffer_load_dwordx4 v237, s[4:7], s74 offen lds
    s_add_u32 m0, s72, 78080
    s_nop 0
    buffer_load_dwordx4 v238, s[4:7], s74 offen lds
    s_add_u32 m0, s72, 79104
    s_nop 0
    buffer_load_dwordx4 v239, s[4:7], s74 offen lds
    s_add_u32 m0, s16, 76032
    s_nop 0
    buffer_load_dwordx4 v244, s[4:7], s74 offen lds
    s_add_u32 m0, s16, 77056
    s_nop 0
    buffer_load_dwordx4 v245, s[4:7], s74 offen lds
    s_add_u32 m0, s16, 78080
    s_nop 0
    buffer_load_dwordx4 v246, s[4:7], s74 offen lds
    s_add_u32 m0, s16, 79104
    s_nop 0
    buffer_load_dwordx4 v247, s[4:7], s74 offen lds
    s_add_u32 m0, s73, 76032
    s_nop 0
    buffer_load_dwordx4 v240, s[8:11], s75 offen lds
    s_add_u32 m0, s73, 88352
    s_nop 0
    buffer_load_dwordx4 v240, s[12:15], s75 offen lds
    s_add_u32 m0, s73, 77056
    s_nop 0
    buffer_load_dwordx4 v241, s[8:11], s75 offen lds
    s_add_u32 m0, s73, 89376
    s_nop 0
    buffer_load_dwordx4 v241, s[12:15], s75 offen lds
    s_add_u32 m0, s73, 78080
    s_nop 0
    buffer_load_dwordx4 v242, s[8:11], s75 offen lds
    s_add_u32 m0, s73, 90400
    s_nop 0
    buffer_load_dwordx4 v242, s[12:15], s75 offen lds
    s_add_u32 m0, s17, 76032
    s_nop 0
    buffer_load_dwordx4 v248, s[8:11], s75 offen lds
    s_add_u32 m0, s17, 88352
    s_nop 0
    buffer_load_dwordx4 v248, s[12:15], s75 offen lds
    s_add_u32 m0, s17, 77056
    s_nop 0
    buffer_load_dwordx4 v249, s[8:11], s75 offen lds
    s_add_u32 m0, s17, 89376
    s_nop 0
    buffer_load_dwordx4 v249, s[12:15], s75 offen lds
    s_add_u32 m0, s17, 78080
    s_nop 0
    buffer_load_dwordx4 v250, s[8:11], s75 offen lds
    s_add_u32 m0, s17, 90400
    s_nop 0
    buffer_load_dwordx4 v250, s[12:15], s75 offen lds
    s_waitcnt vmcnt(20)
    s_barrier
    s_add_u32 s74, s76, 5
    s_and_b32 s74, s74, 7
    s_mul_i32 s75, s74, 176128
    s_lshl_b32 s74, s74, 7
    s_add_u32 m0, s72, 117248
    s_nop 0
    buffer_load_dwordx4 v236, s[4:7], s74 offen lds
    s_add_u32 m0, s72, 118272
    s_nop 0
    buffer_load_dwordx4 v237, s[4:7], s74 offen lds
    s_add_u32 m0, s72, 119296
    s_nop 0
    buffer_load_dwordx4 v238, s[4:7], s74 offen lds
    s_add_u32 m0, s72, 120320
    s_nop 0
    buffer_load_dwordx4 v239, s[4:7], s74 offen lds
    s_add_u32 m0, s16, 117248
    s_nop 0
    buffer_load_dwordx4 v244, s[4:7], s74 offen lds
    s_add_u32 m0, s16, 118272
    s_nop 0
    buffer_load_dwordx4 v245, s[4:7], s74 offen lds
    s_add_u32 m0, s16, 119296
    s_nop 0
    buffer_load_dwordx4 v246, s[4:7], s74 offen lds
    s_add_u32 m0, s16, 120320
    s_nop 0
    buffer_load_dwordx4 v247, s[4:7], s74 offen lds
    s_add_u32 m0, s73, 117248
    s_nop 0
    buffer_load_dwordx4 v240, s[8:11], s75 offen lds
    s_add_u32 m0, s73, 129568
    s_nop 0
    buffer_load_dwordx4 v240, s[12:15], s75 offen lds
    s_add_u32 m0, s73, 118272
    s_nop 0
    buffer_load_dwordx4 v241, s[8:11], s75 offen lds
    s_add_u32 m0, s73, 130592
    s_nop 0
    buffer_load_dwordx4 v241, s[12:15], s75 offen lds
    s_add_u32 m0, s73, 119296
    s_nop 0
    buffer_load_dwordx4 v242, s[8:11], s75 offen lds
    s_add_u32 m0, s73, 131616
    s_nop 0
    buffer_load_dwordx4 v242, s[12:15], s75 offen lds
    s_add_u32 m0, s17, 117248
    s_nop 0
    buffer_load_dwordx4 v248, s[8:11], s75 offen lds
    s_add_u32 m0, s17, 129568
    s_nop 0
    buffer_load_dwordx4 v248, s[12:15], s75 offen lds
    s_add_u32 m0, s17, 118272
    s_nop 0
    buffer_load_dwordx4 v249, s[8:11], s75 offen lds
    s_add_u32 m0, s17, 130592
    s_nop 0
    buffer_load_dwordx4 v249, s[12:15], s75 offen lds
    s_add_u32 m0, s17, 119296
    s_nop 0
    buffer_load_dwordx4 v250, s[8:11], s75 offen lds
    s_add_u32 m0, s17, 131616
    s_nop 0
    buffer_load_dwordx4 v250, s[12:15], s75 offen lds
    s_waitcnt vmcnt(20)
    s_barrier
    s_add_u32 s74, s76, 6
    s_and_b32 s74, s74, 7
    s_mul_i32 s75, s74, 176128
    s_lshl_b32 s74, s74, 7
    s_add_u32 m0, s72, 34816
    s_nop 0
    buffer_load_dwordx4 v236, s[4:7], s74 offen lds
    s_add_u32 m0, s72, 35840
    s_nop 0
    buffer_load_dwordx4 v237, s[4:7], s74 offen lds
    s_add_u32 m0, s72, 36864
    s_nop 0
    buffer_load_dwordx4 v238, s[4:7], s74 offen lds
    s_add_u32 m0, s72, 37888
    s_nop 0
    buffer_load_dwordx4 v239, s[4:7], s74 offen lds
    s_add_u32 m0, s16, 34816
    s_nop 0
    buffer_load_dwordx4 v244, s[4:7], s74 offen lds
    s_add_u32 m0, s16, 35840
    s_nop 0
    buffer_load_dwordx4 v245, s[4:7], s74 offen lds
    s_add_u32 m0, s16, 36864
    s_nop 0
    buffer_load_dwordx4 v246, s[4:7], s74 offen lds
    s_add_u32 m0, s16, 37888
    s_nop 0
    buffer_load_dwordx4 v247, s[4:7], s74 offen lds
    s_add_u32 m0, s73, 34816
    s_nop 0
    buffer_load_dwordx4 v240, s[8:11], s75 offen lds
    s_add_u32 m0, s73, 47136
    s_nop 0
    buffer_load_dwordx4 v240, s[12:15], s75 offen lds
    s_add_u32 m0, s73, 35840
    s_nop 0
    buffer_load_dwordx4 v241, s[8:11], s75 offen lds
    s_add_u32 m0, s73, 48160
    s_nop 0
    buffer_load_dwordx4 v241, s[12:15], s75 offen lds
    s_add_u32 m0, s73, 36864
    s_nop 0
    buffer_load_dwordx4 v242, s[8:11], s75 offen lds
    s_add_u32 m0, s73, 49184
    s_nop 0
    buffer_load_dwordx4 v242, s[12:15], s75 offen lds
    s_add_u32 m0, s17, 34816
    s_nop 0
    buffer_load_dwordx4 v248, s[8:11], s75 offen lds
    s_add_u32 m0, s17, 47136
    s_nop 0
    buffer_load_dwordx4 v248, s[12:15], s75 offen lds
    s_add_u32 m0, s17, 35840
    s_nop 0
    buffer_load_dwordx4 v249, s[8:11], s75 offen lds
    s_add_u32 m0, s17, 48160
    s_nop 0
    buffer_load_dwordx4 v249, s[12:15], s75 offen lds
    s_add_u32 m0, s17, 36864
    s_nop 0
    buffer_load_dwordx4 v250, s[8:11], s75 offen lds
    s_add_u32 m0, s17, 49184
    s_nop 0
    buffer_load_dwordx4 v250, s[12:15], s75 offen lds
    s_waitcnt vmcnt(20)
    s_barrier
    s_add_u32 s74, s76, 7
    s_and_b32 s74, s74, 7
    s_mul_i32 s75, s74, 176128
    s_lshl_b32 s74, s74, 7
    s_add_u32 m0, s72, 76032
    s_nop 0
    buffer_load_dwordx4 v236, s[4:7], s74 offen lds
    s_add_u32 m0, s72, 77056
    s_nop 0
    buffer_load_dwordx4 v237, s[4:7], s74 offen lds
    s_add_u32 m0, s72, 78080
    s_nop 0
    buffer_load_dwordx4 v238, s[4:7], s74 offen lds
    s_add_u32 m0, s72, 79104
    s_nop 0
    buffer_load_dwordx4 v239, s[4:7], s74 offen lds
    s_add_u32 m0, s16, 76032
    s_nop 0
    buffer_load_dwordx4 v244, s[4:7], s74 offen lds
    s_add_u32 m0, s16, 77056
    s_nop 0
    buffer_load_dwordx4 v245, s[4:7], s74 offen lds
    s_add_u32 m0, s16, 78080
    s_nop 0
    buffer_load_dwordx4 v246, s[4:7], s74 offen lds
    s_add_u32 m0, s16, 79104
    s_nop 0
    buffer_load_dwordx4 v247, s[4:7], s74 offen lds
    s_add_u32 m0, s73, 76032
    s_nop 0
    buffer_load_dwordx4 v240, s[8:11], s75 offen lds
    s_add_u32 m0, s73, 88352
    s_nop 0
    buffer_load_dwordx4 v240, s[12:15], s75 offen lds
    s_add_u32 m0, s73, 77056
    s_nop 0
    buffer_load_dwordx4 v241, s[8:11], s75 offen lds
    s_add_u32 m0, s73, 89376
    s_nop 0
    buffer_load_dwordx4 v241, s[12:15], s75 offen lds
    s_add_u32 m0, s73, 78080
    s_nop 0
    buffer_load_dwordx4 v242, s[8:11], s75 offen lds
    s_add_u32 m0, s73, 90400
    s_nop 0
    buffer_load_dwordx4 v242, s[12:15], s75 offen lds
    s_add_u32 m0, s17, 76032
    s_nop 0
    buffer_load_dwordx4 v248, s[8:11], s75 offen lds
    s_add_u32 m0, s17, 88352
    s_nop 0
    buffer_load_dwordx4 v248, s[12:15], s75 offen lds
    s_add_u32 m0, s17, 77056
    s_nop 0
    buffer_load_dwordx4 v249, s[8:11], s75 offen lds
    s_add_u32 m0, s17, 89376
    s_nop 0
    buffer_load_dwordx4 v249, s[12:15], s75 offen lds
    s_add_u32 m0, s17, 78080
    s_nop 0
    buffer_load_dwordx4 v250, s[8:11], s75 offen lds
    s_add_u32 m0, s17, 90400
    s_nop 0
    buffer_load_dwordx4 v250, s[12:15], s75 offen lds
    s_waitcnt vmcnt(20)
    s_barrier
    s_waitcnt vmcnt(0)
A_ldone:
    s_mov_b64 exec, 1
    v_mov_b32 v12, 34092
    v_mov_b32 v13, 1
    ds_add_u32 v12, v13
    s_mov_b64 exec, -1
    s_lshl_b32 s27, s24, 4
    s_add_u32 m0, s23, 0
    s_nop 0
    buffer_load_dwordx4 v4, s[40:43], s27 offen lds
    s_add_u32 s27, s27, 8192
    s_add_u32 m0, s23, 1024
    s_nop 0
    buffer_load_dwordx4 v4, s[40:43], s27 offen lds
    s_add_u32 s24, s24, 4096
    s_cmp_ge_u32 s24, 90112
    s_cselect_b32 s24, s26, s24
    s_lshl_b32 s27, s24, 4
    s_add_u32 m0, s23, 2048
    s_nop 0
    buffer_load_dwordx4 v4, s[40:43], s27 offen lds
    s_add_u32 s27, s27, 8192
    s_add_u32 m0, s23, 3072
    s_nop 0
    buffer_load_dwordx4 v4, s[40:43], s27 offen lds
    s_add_u32 s24, s24, 4096
    s_cmp_ge_u32 s24, 90112
    s_cselect_b32 s24, s26, s24
    s_lshl_b32 s27, s24, 4
    s_add_u32 m0, s23, 4096
    s_nop 0
    buffer_load_dwordx4 v4, s[40:43], s27 offen lds
    s_add_u32 s27, s27, 8192
    s_add_u32 m0, s23, 5120
    s_nop 0
    buffer_load_dwordx4 v4, s[40:43], s27 offen lds
    s_add_u32 s24, s24, 4096
    s_cmp_ge_u32 s24, 90112
    s_cselect_b32 s24, s26, s24
    s_lshl_b32 s27, s24, 4
    s_add_u32 m0, s23, 6144
    s_nop 0
    buffer_load_dwordx4 v4, s[40:43], s27 offen lds
    s_add_u32 s27, s27, 8192
    s_add_u32 m0, s23, 7168
    s_nop 0
    buffer_load_dwordx4 v4, s[40:43], s27 offen lds
    s_add_u32 s24, s24, 4096
    s_cmp_ge_u32 s24, 90112
    s_cselect_b32 s24, s26, s24
    s_lshl_b32 s27, s24, 4
    s_add_u32 m0, s23, 8192
    s_nop 0
    buffer_load_dwordx4 v4, s[40:43], s27 offen lds
    s_add_u32 s27, s27, 8192
    s_add_u32 m0, s23, 9216
    s_nop 0
    buffer_load_dwordx4 v4, s[40:43], s27 offen lds
    s_add_u32 s24, s24, 4096
    s_cmp_ge_u32 s24, 90112
    s_cselect_b32 s24, s26, s24
    s_branch A_gemm2
A_noload:
    s_barrier
    s_barrier
    s_barrier
    s_barrier
    s_barrier
    s_barrier
    s_barrier
    s_branch A_ldone
A_side:
    s_bfe_u32 s67, s65, 0x10002
    s_lshr_b32 s68, s65, 3
    s_and_b32 s23, s77, 1
    s_lshl_b32 s23, s23, 2
    v_lshrrev_b32 v6, 4, v1
    v_bfe_u32 v7, v1, 2, 2
    v_bfe_u32 v8, v1, 1, 1
    v_lshlrev_b32 v10, 4, v6
    v_lshl_add_u32 v10, v8, 3, v10
    v_add_u32 v10, v10, v7
    v_bfe_u32 v11, v10, 1, 3
    v_xor_b32 v11, s23, v11
    v_lshlrev_b32 v10, 7, v10
    v_lshl_add_u32 v10, v11, 4, v10
    v_and_b32 v11, 1, v1
    v_lshl_add_u32 v10, v11, 3, v10
    s_lshl_b32 s69, s67, 13
    s_add_u32 s69, s69, 34816
    v_add_u32 v144, s69, v10
    v_add_u32 v145, 41216, v144
    v_add_u32 v146, 82432, v144
    v_and_b32 v10, 7, v1
    v_mul_u32_u24 v10, 4224, v10
    v_lshrrev_b32 v11, 3, v1
    v_lshl_add_u32 v10, v11, 4, v10
    s_lshl_b32 s70, s67, 7
    s_lshl_b32 s71, s64, 8
    s_add_u32 s70, s70, s71
    v_add_u32 v10, s70, v10
    s_add_u32 s28, s60, 0x800000
    s_addc_u32 s29, s61, 0
    s_mov_b32 s30, 0x210000
    s_mov_b32 s31, 0x20000
    v_mov_b32 v2, 0
    s_barrier
    s_cmp_lg_u32 s68, 0
    s_cbranch_scc1 nout19
    v_xor_b32 v168, 0, v144
    ds_read_b64_tr_b16 v[112:113], v168 offset:0
    v_xor_b32 v169, 32, v144
    ds_read_b64_tr_b16 v[114:115], v169 offset:512
    v_xor_b32 v170, 16, v144
    ds_read_b64_tr_b16 v[116:117], v170 offset:0
    v_xor_b32 v171, 48, v144
    ds_read_b64_tr_b16 v[118:119], v171 offset:512
    v_xor_b32 v172, 32, v144
    ds_read_b64_tr_b16 v[120:121], v172 offset:0
    v_xor_b32 v173, 0, v144
    ds_read_b64_tr_b16 v[122:123], v173 offset:512
    v_xor_b32 v174, 48, v144
    ds_read_b64_tr_b16 v[124:125], v174 offset:0
    v_xor_b32 v175, 16, v144
    ds_read_b64_tr_b16 v[126:127], v175 offset:512
    s_waitcnt lgkmcnt(0)
    s_add_u32 s74, s76, 0
    s_and_b32 s74, s74, 7
    s_lshl_b32 s74, s74, 3
    s_xor_b32 s75, s23, 0
    s_add_u32 s75, s75, s74
    s_mul_i32 s75, s75, 33792
    buffer_store_dwordx4 v[112:115], v10, s[28:31], s75 offen sc1
    s_xor_b32 s75, s23, 1
    s_add_u32 s75, s75, s74
    s_mul_i32 s75, s75, 33792
    buffer_store_dwordx4 v[116:119], v10, s[28:31], s75 offen sc1
    s_xor_b32 s75, s23, 2
    s_add_u32 s75, s75, s74
    s_mul_i32 s75, s75, 33792
    buffer_store_dwordx4 v[120:123], v10, s[28:31], s75 offen sc1
    s_xor_b32 s75, s23, 3
    s_add_u32 s75, s75, s74
    s_mul_i32 s75, s75, 33792
    buffer_store_dwordx4 v[124:127], v10, s[28:31], s75 offen sc1
nout19:
    global_load_dwordx2 v[4:5], v2, s[58:59] sc1
    s_barrier
    s_cmp_lg_u32 s68, 1
    s_cbranch_scc1 nout20
    v_xor_b32 v168, 0, v145
    ds_read_b64_tr_b16 v[112:113], v168 offset:0
    v_xor_b32 v169, 32, v145
    ds_read_b64_tr_b16 v[114:115], v169 offset:512
    v_xor_b32 v170, 16, v145
    ds_read_b64_tr_b16 v[116:117], v170 offset:0
    v_xor_b32 v171, 48, v145
    ds_read_b64_tr_b16 v[118:119], v171 offset:512
    v_xor_b32 v172, 32, v145
    ds_read_b64_tr_b16 v[120:121], v172 offset:0
    v_xor_b32 v173, 0, v145
    ds_read_b64_tr_b16 v[122:123], v173 offset:512
    v_xor_b32 v174, 48, v145
    ds_read_b64_tr_b16 v[124:125], v174 offset:0
    v_xor_b32 v175, 16, v145
    ds_read_b64_tr_b16 v[126:127], v175 offset:512
    s_waitcnt lgkmcnt(0)
    s_add_u32 s74, s76, 1
    s_and_b32 s74, s74, 7
    s_lshl_b32 s74, s74, 3
    s_xor_b32 s75, s23, 0
    s_add_u32 s75, s75, s74
    s_mul_i32 s75, s75, 33792
    buffer_store_dwordx4 v[112:115], v10, s[28:31], s75 offen sc1
    s_xor_b32 s75, s23, 1
    s_add_u32 s75, s75, s74
    s_mul_i32 s75, s75, 33792
    buffer_store_dwordx4 v[116:119], v10, s[28:31], s75 offen sc1
    s_xor_b32 s75, s23, 2
    s_add_u32 s75, s75, s74
    s_mul_i32 s75, s75, 33792
    buffer_store_dwordx4 v[120:123], v10, s[28:31], s75 offen sc1
    s_xor_b32 s75, s23, 3
    s_add_u32 s75, s75, s74
    s_mul_i32 s75, s75, 33792
    buffer_store_dwordx4 v[124:127], v10, s[28:31], s75 offen sc1
nout20:
    s_barrier
    s_barrier
    s_waitcnt vmcnt(0)
tag21:
    v_readfirstlane_b32 s19, v5
    s_cmp_lg_u32 s19, 0
    s_cbranch_scc1 tagok21
    s_sub_u32 s101, s101, 1
    s_cmp_lt_i32 s101, 0
    s_cbranch_scc1 tagok21
    s_sleep 4
    global_load_dwordx2 v[4:5], v2, s[58:59] sc1
    s_waitcnt vmcnt(0)
    s_branch tag21
tagok21:
    v_mov_b32 v3, 34080
    ds_write_b64 v3, v[4:5]
    s_add_u32 s20, s76, s68
    s_lshl_b32 s20, s20, 4
    s_add_u32 s20, s20, s64
    s_lshl_b32 s20, s20, 1
    s_add_u32 s20, s20, s67
    s_lshl_b32 s20, s20, 1
    s_add_u32 s20, s20, s77
    s_lshl_b32 s20, s20, 7
    s_add_u32 s20, s20, -128
    s_add_u32 s28, s60, 0x1120000
    s_addc_u32 s29, s61, 0
    s_mov_b32 s30, 0x3a080
    s_mov_b32 s31, 0x20000
    s_mov_b64 exec, 1
    buffer_store_dwordx2 v[4:5], v2, s[28:31], s20 offen sc1
    s_mov_b64 exec, -1
    s_waitcnt lgkmcnt(0)
    s_barrier
    s_mov_b32 s36, s60
    s_mov_b32 s37, s61
    s_mov_b32 s38, 0x560000
    s_mov_b32 s39, 0x20000
    s_mov_b32 s40, s52
    s_mov_b32 s41, s53
    s_mov_b32 s42, 0x158000
    s_mov_b32 s43, 0x20000
    v_lshlrev_b32 v6, 4, v1
    s_and_b32 s20, s77, 1
    s_lshl_b32 s21, s78, 1
    s_add_u32 s21, s21, s20
    s_mul_i32 s22, s21, 88064
    v_add_u32 v2, s22, v6
    s_xor_b32 s21, s21, 1
    s_mul_i32 s22, s21, 88064
    v_add_u32 v3, s22, v6
    s_mul_i32 s23, s77, 10240
    s_lshr_b32 s20, s77, 1
    s_add_u32 s23, s23, 117248
    v_lshrrev_b32 v7, 3, v1
    v_bfe_u32 v8, v1, 4, 1
    v_lshlrev_b32 v8, 2, v8
    v_and_b32 v4, 7, v1
    v_xor_b32 v4, v4, v8
    v_lshlrev_b32 v4, 4, v4
    v_lshl_add_u32 v4, v7, 10, v4
    s_lshl_b32 s21, s79, 7
    v_add_u32 v4, s21, v4
    v_lshrrev_b32 v7, 5, v1
    v_bfe_u32 v8, v1, 2, 2
    v_lshl_add_u32 v7, v7, 2, v8
    v_lshlrev_b32 v5, 7, v7
    v_bfe_u32 v7, v1, 3, 1
    v_xor_b32 v7, s20, v7
    v_lshl_add_u32 v5, v7, 6, v5
    v_and_b32 v7, 1, v1
    v_lshl_add_u32 v5, v7, 5, v5
    v_bfe_u32 v7, v1, 4, 1
    v_lshl_add_u32 v5, v7, 4, v5
    v_bfe_u32 v7, v1, 1, 1
    v_lshl_add_u32 v5, v7, 3, v5
    v_add_u32 v5, s23, v5
    v_xor_b32 v9, 64, v5
    s_lshr_b32 s25, s63, 3
    s_lshl_b32 s25, s25, 1
    s_add_u32 s24, s79, s25
    s_mul_i32 s24, s24, 11
    s_lshr_b32 s24, s24, 2
    s_cmp_ge_u32 s24, 22
    s_cselect_b32 s25, 22, 0
    s_sub_u32 s24, s24, s25
    s_lshl_b32 s24, s24, 2
    s_add_u32 s24, s24, s77
    s_lshl_b32 s24, s24, 10
    s_mov_b32 s25, s24
    s_lshl_b32 s26, s77, 10
    s_barrier
    v_mov_b32 v12, 34080
    ds_read_b64 v[10:11], v12
    s_waitcnt lgkmcnt(0)
    v_readfirstlane_b32 s18, v10
    v_readfirstlane_b32 s19, v11
    s_add_u32 s28, s60, 0x1120000
    s_addc_u32 s29, s61, 0
    s_mov_b32 s30, 0x3a080
    s_mov_b32 s31, 0x20000
    v_lshlrev_b32 v15, 7, v1
    s_lshr_b32 s17, s66, 5
    s_lshl_b32 s17, s17, 13
    s_add_u32 s17, s17, 128
    buffer_load_dwordx2 v[22:23], v15, s[28:31], s17 offen sc1
    s_barrier
    s_waitcnt vmcnt(0)
chk22:
    v_cmp_ne_u64 vcc, s[18:19], v[22:23]
    s_cbranch_vccz ok22
    s_sub_u32 s101, s101, 1
    s_cmp_lt_i32 s101, 0
    s_cbranch_scc1 ok22
    s_sleep 8
    buffer_load_dwordx2 v[22:23], v15, s[28:31], s17 offen sc1
    s_waitcnt vmcnt(0)
    s_branch chk22
ok22:
    s_add_u32 s12, s60, 0x800000
    s_addc_u32 s13, s61, 0
    s_mov_b32 s14, 0x210000
    s_mov_b32 s15, 0x20000
    s_lshl_b32 s20, s66, 1
    s_and_b32 s21, s77, 1
    s_add_u32 s20, s20, s21
    s_mul_i32 s20, s20, 4224
    buffer_load_dwordx4 v[64:67], v6, s[12:15], s20 offen offset:0 sc1
    buffer_load_dwordx4 v[68:71], v6, s[12:15], s20 offen offset:1024 sc1
    buffer_load_dwordx4 v[72:75], v6, s[12:15], s20 offen offset:2048 sc1
    buffer_load_dwordx4 v[76:79], v6, s[12:15], s20 offen offset:3072 sc1
    s_lshl_b32 s27, s24, 4
    s_add_u32 m0, s23, 0
    s_nop 0
    buffer_load_dwordx4 v4, s[40:43], s27 offen lds
    s_add_u32 s27, s27, 8192
    s_add_u32 m0, s23, 1024
    s_nop 0
    buffer_load_dwordx4 v4, s[40:43], s27 offen lds
    s_add_u32 s24, s24, 4096
    s_cmp_ge_u32 s24, 90112
    s_cselect_b32 s24, s26, s24
    s_lshl_b32 s27, s24, 4
    s_add_u32 m0, s23, 2048
    s_nop 0
    buffer_load_dwordx4 v4, s[40:43], s27 offen lds
    s_add_u32 s27, s27, 8192
    s_add_u32 m0, s23, 3072
    s_nop 0
    buffer_load_dwordx4 v4, s[40:43], s27 offen lds
    s_add_u32 s24, s24, 4096
    s_cmp_ge_u32 s24, 90112
    s_cselect_b32 s24, s26, s24
    s_lshl_b32 s27, s24, 4
    s_add_u32 m0, s23, 4096
    s_nop 0
    buffer_load_dwordx4 v4, s[40:43], s27 offen lds
    s_add_u32 s27, s27, 8192
    s_add_u32 m0, s23, 5120
    s_nop 0
    buffer_load_dwordx4 v4, s[40:43], s27 offen lds
    s_add_u32 s24, s24, 4096
    s_cmp_ge_u32 s24, 90112
    s_cselect_b32 s24, s26, s24
    s_lshl_b32 s27, s24, 4
    s_add_u32 m0, s23, 6144
    s_nop 0
    buffer_load_dwordx4 v4, s[40:43], s27 offen lds
    s_add_u32 s27, s27, 8192
    s_add_u32 m0, s23, 7168
    s_nop 0
    buffer_load_dwordx4 v4, s[40:43], s27 offen lds
    s_add_u32 s24, s24, 4096
    s_cmp_ge_u32 s24, 90112
    s_cselect_b32 s24, s26, s24
    s_lshl_b32 s27, s24, 4
    s_add_u32 m0, s23, 8192
    s_nop 0
    buffer_load_dwordx4 v4, s[40:43], s27 offen lds
    s_add_u32 s27, s27, 8192
    s_add_u32 m0, s23, 9216
    s_nop 0
    buffer_load_dwordx4 v4, s[40:43], s27 offen lds
    s_add_u32 s24, s24, 4096
    s_cmp_ge_u32 s24, 90112
    s_cselect_b32 s24, s26, s24
    v_mov_b32 v12, 34088
lw23:
    ds_read_b32 v13, v12
    s_waitcnt lgkmcnt(0)
    v_readfirstlane_b32 s22, v13
    s_cmp_ge_u32 s22, 4
    s_cbranch_scc1 lwok23
    s_sub_u32 s101, s101, 1
    s_cmp_lt_i32 s101, 0
    s_cbranch_scc1 lwok23
    s_branch lw23
lwok23:
    s_and_b32 s21, s77, 1
    s_mul_i32 s20, s21, 4608
    s_add_u32 s20, s20, 34816
    v_add_u32 v7, s20, v6
    v_mov_b32 v16, 0
    v_mov_b32 v17, 0
    v_mov_b32 v18, 0
    v_mov_b32 v19, 0
    ds_write_b128 v7, v[16:19]
    s_waitcnt vmcnt(10)
    ds_write_b128 v7, v[64:67] offset:480
    ds_write_b128 v7, v[68:71] offset:1504
    ds_write_b128 v7, v[72:75] offset:2528
    ds_write_b128 v7, v[76:79] offset:3552
A_gemm2:
    v_lshlrev_b32 v18, 4, v180
    ds_read2st64_b32 v[20:21], v184 offset0:0 offset1:17
    ds_read2st64_b32 v[22:23], v185 offset0:0 offset1:17
    ds_read2st64_b32 v[24:25], v186 offset0:0 offset1:17
    ds_read2st64_b32 v[26:27], v187 offset0:0 offset1:17
    ds_read2st64_b32 v[28:29], v188 offset0:0 offset1:17
    ds_read2st64_b32 v[30:31], v189 offset0:0 offset1:17
    ds_read2st64_b32 v[32:33], v190 offset0:0 offset1:17
    ds_read2st64_b32 v[34:35], v191 offset0:0 offset1:17
    ds_read2st64_b32 v[36:37], v192 offset0:0 offset1:17
    ds_read2st64_b32 v[38:39], v184 offset0:34 offset1:51
    ds_read2st64_b32 v[40:41], v185 offset0:34 offset1:51
    ds_read2st64_b32 v[42:43], v186 offset0:34 offset1:51
    ds_read2st64_b32 v[44:45], v187 offset0:34 offset1:51
    ds_read2st64_b32 v[46:47], v188 offset0:34 offset1:51
    ds_read2st64_b32 v[48:49], v189 offset0:34 offset1:51
    ds_read2st64_b32 v[50:51], v190 offset0:34 offset1:51
    ds_read2st64_b32 v[52:53], v191 offset0:34 offset1:51
    ds_read2st64_b32 v[54:55], v192 offset0:34 offset1:51
    v_cmp_ne_u32 vcc, 0xff, v180
    s_waitcnt lgkmcnt(9)
    v_add_f32 v20, v20, v21
    v_add_f32 v22, v22, v23
    v_add_f32 v24, v24, v25
    v_add_f32 v26, v26, v27
    v_add_f32 v28, v28, v29
    v_add_f32 v30, v30, v31
    v_add_f32 v32, v32, v33
    v_add_f32 v34, v34, v35
    v_add_f32 v36, v36, v37
    v_cndmask_b32 v36, 0, v36, vcc
    v_cvt_pk_bf16_f32 v60, v20, v22
    v_cvt_pk_bf16_f32 v61, v24, v26
    v_cvt_pk_bf16_f32 v62, v28, v30
    v_cvt_pk_bf16_f32 v63, v32, v34
    v_cvt_pk_bf16_f32 v56, v22, v24
    v_cvt_pk_bf16_f32 v57, v26, v28
    v_cvt_pk_bf16_f32 v58, v30, v32
    v_cvt_pk_bf16_f32 v59, v34, v36
    ds_write_b128 v18, v[56:59] offset:17408
    ds_write_b128 v18, v[60:63] offset:21568
    s_waitcnt lgkmcnt(2)
    v_add_f32 v38, v38, v39
    v_add_f32 v40, v40, v41
    v_add_f32 v42, v42, v43
    v_add_f32 v44, v44, v45
    v_add_f32 v46, v46, v47
    v_add_f32 v48, v48, v49
    v_add_f32 v50, v50, v51
    v_add_f32 v52, v52, v53
    v_add_f32 v54, v54, v55
    v_cndmask_b32 v54, 0, v54, vcc
    v_cvt_pk_bf16_f32 v68, v38, v40
    v_cvt_pk_bf16_f32 v69, v42, v44
    v_cvt_pk_bf16_f32 v70, v46, v48
    v_cvt_pk_bf16_f32 v71, v50, v52
    v_cvt_pk_bf16_f32 v64, v40, v42
    v_cvt_pk_bf16_f32 v65, v44, v46
    v_cvt_pk_bf16_f32 v66, v48, v50
    v_cvt_pk_bf16_f32 v67, v52, v54
    ds_write_b128 v18, v[64:67] offset:25728
    ds_write_b128 v18, v[68:71] offset:29888
    v_lshrrev_b32 v19, 2, v1
    v_mul_u32_u24 v19, 4160, v19
    v_and_b32 v16, 3, v1
    v_lshl_add_u32 v19, v16, 4, v19
    v_mov_b32 v88, 0
    v_mov_b32 v89, 0
    v_mov_b32 v90, 0
    v_mov_b32 v91, 0
    s_mov_b64 exec, 0xffff
    ds_write_b128 v19, v[88:91] offset:21504
    s_mov_b64 exec, -1
    s_waitcnt lgkmcnt(0)
    s_mov_b64 exec, 1
    v_mov_b32 v12, 34076
    v_mov_b32 v13, 1
    ds_add_u32 v12, v13
    s_mov_b64 exec, -1
A_gemm2b:
    v_mov_b32 v12, 34080
    ds_read_b64 v[10:11], v12
    s_waitcnt lgkmcnt(0)
    v_readfirstlane_b32 s18, v10
    v_readfirstlane_b32 s19, v11
    s_add_u32 s28, s60, 0x1120000
    s_addc_u32 s29, s61, 0
    s_mov_b32 s30, 0x3a080
    s_mov_b32 s31, 0x20000
    v_lshlrev_b32 v14, 7, v1
    v_lshlrev_b32 v15, 3, v1
    s_and_b32 s16, s78, -1
    s_lshl_b32 s16, s16, 12
    s_add_u32 s16, s16, 65664
    s_lshl_b32 s17, s79, 1
    s_lshr_b32 s20, s78, 2
    s_lshr_b32 s21, s78, 3
    s_xor_b32 s20, s20, s21
    s_and_b32 s20, s20, 1
    s_add_u32 s17, s17, s20
    s_lshl_b32 s17, s17, 9
    s_add_u32 s17, s17, 196736
    s_add_u32 s54, s23, -41216
    v_add_u32 v10, 4294926080, v5
    v_add_u32 v11, 4294926080, v9
    s_waitcnt vmcnt(8)
    ds_read_b64_tr_b16 v[80:81], v5 offset:0
    ds_read_b64_tr_b16 v[82:83], v5 offset:1024
    ds_read_b64_tr_b16 v[84:85], v9 offset:0
    ds_read_b64_tr_b16 v[86:87], v9 offset:1024
    s_waitcnt vmcnt(6)
    ds_read_b64_tr_b16 v[88:89], v5 offset:2048
    ds_read_b64_tr_b16 v[90:91], v5 offset:3072
    ds_read_b64_tr_b16 v[92:93], v9 offset:2048
    ds_read_b64_tr_b16 v[94:95], v9 offset:3072
    s_waitcnt vmcnt(4)
    ds_read_b64_tr_b16 v[96:97], v5 offset:4096
    ds_read_b64_tr_b16 v[98:99], v5 offset:5120
    ds_read_b64_tr_b16 v[100:101], v9 offset:4096
    ds_read_b64_tr_b16 v[102:103], v9 offset:5120
    s_waitcnt vmcnt(2)
    ds_read_b64_tr_b16 v[104:105], v5 offset:6144
    ds_read_b64_tr_b16 v[106:107], v5 offset:7168
    ds_read_b64_tr_b16 v[108:109], v9 offset:6144
    ds_read_b64_tr_b16 v[110:111], v9 offset:7168
    s_waitcnt vmcnt(0)
    ds_read_b64_tr_b16 v[112:113], v5 offset:8192
    ds_read_b64_tr_b16 v[114:115], v5 offset:9216
    ds_read_b64_tr_b16 v[116:117], v9 offset:8192
    ds_read_b64_tr_b16 v[118:119], v9 offset:9216
    v_mov_b32 v12, 34100
lw24:
    ds_read_b32 v13, v12
    s_waitcnt lgkmcnt(0)
    v_readfirstlane_b32 s22, v13
    s_cmp_ge_u32 s22, 4
    s_cbranch_scc1 lwok24
    s_sub_u32 s101, s101, 1
    s_cmp_lt_i32 s101, 0
    s_cbranch_scc1 lwok24
    s_branch lw24
lwok24:
    s_lshl_b32 s27, s24, 4
    s_add_u32 m0, s54, 0
    s_nop 0
    buffer_load_dwordx4 v4, s[40:43], s27 offen lds
    s_add_u32 s27, s27, 8192
    s_add_u32 m0, s54, 1024
    s_nop 0
    buffer_load_dwordx4 v4, s[40:43], s27 offen lds
    s_add_u32 s24, s24, 4096
    s_cmp_ge_u32 s24, 90112
    s_cselect_b32 s24, s26, s24
    s_lshl_b32 s27, s24, 4
    s_add_u32 m0, s54, 2048
    s_nop 0
    buffer_load_dwordx4 v4, s[40:43], s27 offen lds
    s_add_u32 s27, s27, 8192
    s_add_u32 m0, s54, 3072
    s_nop 0
    buffer_load_dwordx4 v4, s[40:43], s27 offen lds
    s_add_u32 s24, s24, 4096
    s_cmp_ge_u32 s24, 90112
    s_cselect_b32 s24, s26, s24
    s_lshl_b32 s27, s24, 4
    s_add_u32 m0, s54, 4096
    s_nop 0
    buffer_load_dwordx4 v4, s[40:43], s27 offen lds
    s_add_u32 s27, s27, 8192
    s_add_u32 m0, s54, 5120
    s_nop 0
    buffer_load_dwordx4 v4, s[40:43], s27 offen lds
    s_add_u32 s24, s24, 4096
    s_cmp_ge_u32 s24, 90112
    s_cselect_b32 s24, s26, s24
    s_lshl_b32 s27, s24, 4
    s_add_u32 m0, s54, 6144
    s_nop 0
    buffer_load_dwordx4 v4, s[40:43], s27 offen lds
    s_add_u32 s27, s27, 8192
    s_add_u32 m0, s54, 7168
    s_nop 0
    buffer_load_dwordx4 v4, s[40:43], s27 offen lds
    s_add_u32 s24, s24, 4096
    s_cmp_ge_u32 s24, 90112
    s_cselect_b32 s24, s26, s24
    s_lshl_b32 s27, s24, 4
    s_add_u32 m0, s54, 8192
    s_nop 0
    buffer_load_dwordx4 v4, s[40:43], s27 offen lds
    s_add_u32 s27, s27, 8192
    s_add_u32 m0, s54, 9216
    s_nop 0
    buffer_load_dwordx4 v4, s[40:43], s27 offen lds
    s_add_u32 s24, s24, 4096
    s_cmp_ge_u32 s24, 90112
    s_cselect_b32 s24, s26, s24
    s_lshl_b32 s27, s24, 4
    s_add_u32 m0, s23, 0
    s_nop 0
    buffer_load_dwordx4 v4, s[40:43], s27 offen lds
    s_add_u32 s27, s27, 8192
    s_add_u32 m0, s23, 1024
    s_nop 0
    buffer_load_dwordx4 v4, s[40:43], s27 offen lds
    s_add_u32 s24, s24, 4096
    s_cmp_ge_u32 s24, 90112
    s_cselect_b32 s24, s26, s24
    s_lshl_b32 s27, s24, 4
    s_add_u32 m0, s23, 2048
    s_nop 0
    buffer_load_dwordx4 v4, s[40:43], s27 offen lds
    s_add_u32 s27, s27, 8192
    s_add_u32 m0, s23, 3072
    s_nop 0
    buffer_load_dwordx4 v4, s[40:43], s27 offen lds
    s_add_u32 s24, s24, 4096
    s_cmp_ge_u32 s24, 90112
    s_cselect_b32 s24, s26, s24
    s_lshl_b32 s27, s24, 4
    s_add_u32 m0, s23, 4096
    s_nop 0
    buffer_load_dwordx4 v4, s[40:43], s27 offen lds
    s_add_u32 s27, s27, 8192
    s_add_u32 m0, s23, 5120
    s_nop 0
    buffer_load_dwordx4 v4, s[40:43], s27 offen lds
    s_add_u32 s24, s24, 4096
    s_cmp_ge_u32 s24, 90112
    s_cselect_b32 s24, s26, s24
    s_lshl_b32 s27, s24, 4
    s_add_u32 m0, s23, 6144
    s_nop 0
    buffer_load_dwordx4 v4, s[40:43], s27 offen lds
    s_add_u32 s27, s27, 8192
    s_add_u32 m0, s23, 7168
    s_nop 0
    buffer_load_dwordx4 v4, s[40:43], s27 offen lds
    s_add_u32 s24, s24, 4096
    s_cmp_ge_u32 s24, 90112
    s_cselect_b32 s24, s26, s24
    s_lshl_b32 s27, s24, 4
    s_add_u32 m0, s23, 8192
    s_nop 0
    buffer_load_dwordx4 v4, s[40:43], s27 offen lds
    s_add_u32 s27, s27, 8192
    s_add_u32 m0, s23, 9216
    s_nop 0
    buffer_load_dwordx4 v4, s[40:43], s27 offen lds
    s_add_u32 s24, s24, 4096
    s_cmp_ge_u32 s24, 90112
    s_cselect_b32 s24, s26, s24
    s_waitcnt vmcnt(18)
    ds_read_b64_tr_b16 v[120:121], v10 offset:0
    ds_read_b64_tr_b16 v[122:123], v10 offset:1024
    ds_read_b64_tr_b16 v[124:125], v11 offset:0
    ds_read_b64_tr_b16 v[126:127], v11 offset:1024
    s_waitcnt vmcnt(16)
    ds_read_b64_tr_b16 v[128:129], v10 offset:2048
    ds_read_b64_tr_b16 v[130:131], v10 offset:3072
    ds_read_b64_tr_b16 v[132:133], v11 offset:2048
    ds_read_b64_tr_b16 v[134:135], v11 offset:3072
    s_waitcnt lgkmcnt(4)
    s_lshl_b32 s27, s24, 4
    s_add_u32 m0, s54, 0
    s_nop 0
    buffer_load_dwordx4 v4, s[40:43], s27 offen lds
    s_add_u32 s27, s27, 8192
    s_add_u32 m0, s54, 1024
    s_nop 0
    buffer_load_dwordx4 v4, s[40:43], s27 offen lds
    s_add_u32 s24, s24, 4096
    s_cmp_ge_u32 s24, 90112
    s_cselect_b32 s24, s26, s24
    s_waitcnt vmcnt(16)
    ds_read_b64_tr_b16 v[136:137], v10 offset:4096
    ds_read_b64_tr_b16 v[138:139], v10 offset:5120
    ds_read_b64_tr_b16 v[140:141], v11 offset:4096
    ds_read_b64_tr_b16 v[142:143], v11 offset:5120
    s_waitcnt lgkmcnt(4)
    s_lshl_b32 s27, s24, 4
    s_add_u32 m0, s54, 2048
    s_nop 0
    buffer_load_dwordx4 v4, s[40:43], s27 offen lds
    s_add_u32 s27, s27, 8192
    s_add_u32 m0, s54, 3072
    s_nop 0
    buffer_load_dwordx4 v4, s[40:43], s27 offen lds
    s_add_u32 s24, s24, 4096
    s_cmp_ge_u32 s24, 90112
    s_cselect_b32 s24, s26, s24
    s_waitcnt vmcnt(16)
    ds_read_b64_tr_b16 v[144:145], v10 offset:6144
    ds_read_b64_tr_b16 v[146:147], v10 offset:7168
    ds_read_b64_tr_b16 v[148:149], v11 offset:6144
    ds_read_b64_tr_b16 v[150:151], v11 offset:7168
    s_waitcnt vmcnt(14)
    ds_read_b64_tr_b16 v[152:153], v10 offset:8192
    ds_read_b64_tr_b16 v[154:155], v10 offset:9216
    ds_read_b64_tr_b16 v[156:157], v11 offset:8192
    ds_read_b64_tr_b16 v[158:159], v11 offset:9216
    s_waitcnt vmcnt(12)
    ds_read_b64_tr_b16 v[160:161], v5 offset:0
    ds_read_b64_tr_b16 v[162:163], v5 offset:1024
    ds_read_b64_tr_b16 v[164:165], v9 offset:0
    ds_read_b64_tr_b16 v[166:167], v9 offset:1024
    s_waitcnt vmcnt(10)
    ds_read_b64_tr_b16 v[168:169], v5 offset:2048
    ds_read_b64_tr_b16 v[170:171], v5 offset:3072
    ds_read_b64_tr_b16 v[172:173], v9 offset:2048
    ds_read_b64_tr_b16 v[174:175], v9 offset:3072
    s_waitcnt lgkmcnt(4)
    s_lshl_b32 s27, s24, 4
    s_add_u32 m0, s23, 0
    s_nop 0
    buffer_load_dwordx4 v4, s[40:43], s27 offen lds
    s_add_u32 s27, s27, 8192
    s_add_u32 m0, s23, 1024
    s_nop 0
    buffer_load_dwordx4 v4, s[40:43], s27 offen lds
    s_add_u32 s24, s24, 4096
    s_cmp_ge_u32 s24, 90112
    s_cselect_b32 s24, s26, s24
    s_waitcnt vmcnt(10)
    ds_read_b64_tr_b16 v[176:177], v5 offset:4096
    ds_read_b64_tr_b16 v[178:179], v5 offset:5120
    ds_read_b64_tr_b16 v[180:181], v9 offset:4096
    ds_read_b64_tr_b16 v[182:183], v9 offset:5120
    s_waitcnt lgkmcnt(4)
    s_lshl_b32 s27, s24, 4
    s_add_u32 m0, s23, 2048
    s_nop 0
    buffer_load_dwordx4 v4, s[40:43], s27 offen lds
    s_add_u32 s27, s27, 8192
    s_add_u32 m0, s23, 3072
    s_nop 0
    buffer_load_dwordx4 v4, s[40:43], s27 offen lds
    s_add_u32 s24, s24, 4096
    s_cmp_ge_u32 s24, 90112
    s_cselect_b32 s24, s26, s24
    s_waitcnt vmcnt(10)
    ds_read_b64_tr_b16 v[184:185], v5 offset:6144
    ds_read_b64_tr_b16 v[186:187], v5 offset:7168
    ds_read_b64_tr_b16 v[188:189], v9 offset:6144
    ds_read_b64_tr_b16 v[190:191], v9 offset:7168
    s_waitcnt lgkmcnt(4)
    s_lshl_b32 s27, s24, 4
    s_add_u32 m0, s23, 4096
    s_nop 0
    buffer_load_dwordx4 v4, s[40:43], s27 offen lds
    s_add_u32 s27, s27, 8192
    s_add_u32 m0, s23, 5120
    s_nop 0
    buffer_load_dwordx4 v4, s[40:43], s27 offen lds
    s_add_u32 s24, s24, 4096
    s_cmp_ge_u32 s24, 90112
    s_cselect_b32 s24, s26, s24
    s_waitcnt vmcnt(10)
    ds_read_b64_tr_b16 v[192:193], v5 offset:8192
    ds_read_b64_tr_b16 v[194:195], v5 offset:9216
    ds_read_b64_tr_b16 v[196:197], v9 offset:8192
    ds_read_b64_tr_b16 v[198:199], v9 offset:9216
    s_cmp_lg_u32 s77, 0
    s_cbranch_scc1 nohp25
    s_mov_b64 exec, 0x3fffffff
    buffer_load_dwordx2 v[22:23], v14, s[28:31], s16 offen sc1
    s_mov_b64 exec, -1
nohp25:
    s_waitcnt lgkmcnt(4)
    s_lshl_b32 s27, s24, 4
    s_add_u32 m0, s23, 6144
    s_nop 0
    buffer_load_dwordx4 v4, s[40:43], s27 offen lds
    s_add_u32 s27, s27, 8192
    s_add_u32 m0, s23, 7168
    s_nop 0
    buffer_load_dwordx4 v4, s[40:43], s27 offen lds
    s_add_u32 s24, s24, 4096
    s_cmp_ge_u32 s24, 90112
    s_cselect_b32 s24, s26, s24
    s_waitcnt vmcnt(10)
    ds_read_b64_tr_b16 v[200:201], v10 offset:0
    ds_read_b64_tr_b16 v[202:203], v10 offset:1024
    ds_read_b64_tr_b16 v[204:205], v11 offset:0
    ds_read_b64_tr_b16 v[206:207], v11 offset:1024
    s_waitcnt lgkmcnt(4)
    s_lshl_b32 s27, s24, 4
    s_add_u32 m0, s23, 8192
    s_nop 0
    buffer_load_dwordx4 v4, s[40:43], s27 offen lds
    s_add_u32 s27, s27, 8192
    s_add_u32 m0, s23, 9216
    s_nop 0
    buffer_load_dwordx4 v4, s[40:43], s27 offen lds
    s_add_u32 s24, s24, 4096
    s_cmp_ge_u32 s24, 90112
    s_cselect_b32 s24, s26, s24
    s_waitcnt vmcnt(10)
    ds_read_b64_tr_b16 v[208:209], v10 offset:2048
    ds_read_b64_tr_b16 v[210:211], v10 offset:3072
    ds_read_b64_tr_b16 v[212:213], v11 offset:2048
    ds_read_b64_tr_b16 v[214:215], v11 offset:3072
    s_cmp_lg_u32 s77, 0
    s_cbranch_scc1 hw26
    s_waitcnt vmcnt(4)
ph26:
    s_mov_b64 exec, 0x3fffffff
    v_cmp_ne_u64 vcc, s[18:19], v[22:23]
    s_cbranch_vccz phok26
    s_sub_u32 s101, s101, 1
    s_cmp_lt_i32 s101, 0
    s_cbranch_scc1 phok26
    buffer_load_dwordx2 v[22:23], v14, s[28:31], s16 offen sc1
    s_waitcnt vmcnt(0)
    s_branch ph26
phok26:
    s_mov_b64 exec, -1
    s_mov_b64 exec, 1
    v_mov_b32 v12, 34096
    v_mov_b32 v13, 1
    ds_add_u32 v12, v13
    s_mov_b64 exec, -1
    s_branch hd26
hw26:
    v_mov_b32 v12, 34096
lw27:
    ds_read_b32 v13, v12
    s_waitcnt lgkmcnt(0)
    v_readfirstlane_b32 s22, v13
    s_cmp_ge_u32 s22, 1
    s_cbranch_scc1 lwok27
    s_sub_u32 s101, s101, 1
    s_cmp_lt_i32 s101, 0
    s_cbranch_scc1 lwok27
    s_branch lw27
lwok27:
hd26:
    s_waitcnt lgkmcnt(0)
    s_min_u32 s27, s25, 87040
    buffer_load_dwordx4 v[216:219], v2, s[36:39], s27 offen sc1
    buffer_load_dwordx4 v[220:223], v3, s[36:39], s27 offen sc1
    s_add_u32 s25, s25, 4096
    s_cmp_ge_u32 s25, 90112
    s_cselect_b32 s25, s26, s25
    s_min_u32 s27, s25, 87040
    buffer_load_dwordx4 v[224:227], v2, s[36:39], s27 offen sc1
    buffer_load_dwordx4 v[228:231], v3, s[36:39], s27 offen sc1
    s_add_u32 s25, s25, 4096
    s_cmp_ge_u32 s25, 90112
    s_cselect_b32 s25, s26, s25
    s_min_u32 s27, s25, 87040
    buffer_load_dwordx4 v[232:235], v2, s[36:39], s27 offen sc1
    buffer_load_dwordx4 v[236:239], v3, s[36:39], s27 offen sc1
    s_add_u32 s25, s25, 4096
    s_cmp_ge_u32 s25, 90112
    s_cselect_b32 s25, s26, s25
    s_min_u32 s27, s25, 87040
    buffer_load_dwordx4 v[240:243], v2, s[36:39], s27 offen sc1
    buffer_load_dwordx4 v[244:247], v3, s[36:39], s27 offen sc1
    s_add_u32 s25, s25, 4096
    s_cmp_ge_u32 s25, 90112
    s_cselect_b32 s25, s26, s25
    s_min_u32 s27, s25, 87040
    buffer_load_dwordx4 v[248:251], v2, s[36:39], s27 offen sc1
    buffer_load_dwordx4 v[252:255], v3, s[36:39], s27 offen sc1
    s_add_u32 s25, s25, 4096
    s_cmp_ge_u32 s25, 90112
    s_cselect_b32 s25, s26, s25
    s_waitcnt vmcnt(8)
    v_mfma_f32_32x32x16_bf16 v[64:79], v[84:87], v[220:223], 0
    v_mfma_f32_32x32x16_bf16 v[48:63], v[84:87], v[216:219], 0
    v_mfma_f32_32x32x16_bf16 v[32:47], v[80:83], v[220:223], 0
    v_mfma_f32_32x32x16_bf16 v[16:31], v[80:83], v[216:219], 0
    s_waitcnt vmcnt(6)
    v_mfma_f32_32x32x16_bf16 v[64:79], v[92:95], v[228:231], v[64:79]
    s_min_u32 s27, s25, 87040
    buffer_load_dwordx4 v[80:83], v2, s[36:39], s27 offen sc1
    buffer_load_dwordx4 v[84:87], v3, s[36:39], s27 offen sc1
    s_add_u32 s25, s25, 4096
    s_cmp_ge_u32 s25, 90112
    s_cselect_b32 s25, s26, s25
    v_mfma_f32_32x32x16_bf16 v[48:63], v[92:95], v[224:227], v[48:63]
    s_min_u32 s27, s25, 87040
    buffer_load_dwordx4 v[216:219], v2, s[36:39], s27 offen sc1
    buffer_load_dwordx4 v[220:223], v3, s[36:39], s27 offen sc1
    s_add_u32 s25, s25, 4096
    s_cmp_ge_u32 s25, 90112
    s_cselect_b32 s25, s26, s25
    v_mfma_f32_32x32x16_bf16 v[32:47], v[88:91], v[228:231], v[32:47]
    v_mfma_f32_32x32x16_bf16 v[16:31], v[88:91], v[224:227], v[16:31]
    s_waitcnt vmcnt(8)
    v_mfma_f32_32x32x16_bf16 v[64:79], v[100:103], v[236:239], v[64:79]
    s_min_u32 s27, s25, 87040
    buffer_load_dwordx4 v[88:91], v2, s[36:39], s27 offen sc1
    buffer_load_dwordx4 v[92:95], v3, s[36:39], s27 offen sc1
    s_add_u32 s25, s25, 4096
    s_cmp_ge_u32 s25, 90112
    s_cselect_b32 s25, s26, s25
    v_mfma_f32_32x32x16_bf16 v[48:63], v[100:103], v[232:235], v[48:63]
    s_min_u32 s27, s25, 87040
    buffer_load_dwordx4 v[224:227], v2, s[36:39], s27 offen sc1
    buffer_load_dwordx4 v[228:231], v3, s[36:39], s27 offen sc1
    s_add_u32 s25, s25, 4096
    s_cmp_ge_u32 s25, 90112
    s_cselect_b32 s25, s26, s25
    v_mfma_f32_32x32x16_bf16 v[32:47], v[96:99], v[236:239], v[32:47]
    v_mfma_f32_32x32x16_bf16 v[16:31], v[96:99], v[232:235], v[16:31]
    s_waitcnt vmcnt(10)
    v_mfma_f32_32x32x16_bf16 v[64:79], v[108:111], v[244:247], v[64:79]
    s_min_u32 s27, s25, 87040
    buffer_load_dwordx4 v[96:99], v2, s[36:39], s27 offen sc1
    buffer_load_dwordx4 v[100:103], v3, s[36:39], s27 offen sc1
    s_add_u32 s25, s25, 4096
    s_cmp_ge_u32 s25, 90112
    s_cselect_b32 s25, s26, s25
    v_mfma_f32_32x32x16_bf16 v[48:63], v[108:111], v[240:243], v[48:63]
    s_min_u32 s27, s25, 87040
    buffer_load_dwordx4 v[232:235], v2, s[36:39], s27 offen sc1
    buffer_load_dwordx4 v[236:239], v3, s[36:39], s27 offen sc1
    s_add_u32 s25, s25, 4096
    s_cmp_ge_u32 s25, 90112
    s_cselect_b32 s25, s26, s25
    v_mfma_f32_32x32x16_bf16 v[32:47], v[104:107], v[244:247], v[32:47]
    v_mfma_f32_32x32x16_bf16 v[16:31], v[104:107], v[240:243], v[16:31]
    s_waitcnt vmcnt(12)
    v_mfma_f32_32x32x16_bf16 v[64:79], v[116:119], v[252:255], v[64:79]
    s_min_u32 s27, s25, 87040
    buffer_load_dwordx4 v[104:107], v2, s[36:39], s27 offen sc1
    buffer_load_dwordx4 v[108:111], v3, s[36:39], s27 offen sc1
    s_add_u32 s25, s25, 4096
    s_cmp_ge_u32 s25, 90112
    s_cselect_b32 s25, s26, s25
    v_mfma_f32_32x32x16_bf16 v[48:63], v[116:119], v[248:251], v[48:63]
    v_mfma_f32_32x32x16_bf16 v[32:47], v[112:115], v[252:255], v[32:47]
    v_mfma_f32_32x32x16_bf16 v[16:31], v[112:115], v[248:251], v[16:31]
    s_waitcnt vmcnt(12)
    v_mfma_f32_32x32x16_bf16 v[64:79], v[124:127], v[84:87], v[64:79]
    s_min_u32 s27, s25, 87040
    buffer_load_dwordx4 v[240:243], v2, s[36:39], s27 offen sc1
    buffer_load_dwordx4 v[244:247], v3, s[36:39], s27 offen sc1
    s_add_u32 s25, s25, 4096
    s_cmp_ge_u32 s25, 90112
    s_cselect_b32 s25, s26, s25
    v_mfma_f32_32x32x16_bf16 v[48:63], v[124:127], v[80:83], v[48:63]
    v_mfma_f32_32x32x16_bf16 v[32:47], v[120:123], v[84:87], v[32:47]
    v_mfma_f32_32x32x16_bf16 v[16:31], v[120:123], v[80:83], v[16:31]
    s_waitcnt vmcnt(12)
    v_mfma_f32_32x32x16_bf16 v[64:79], v[132:135], v[220:223], v[64:79]
    s_min_u32 s27, s25, 87040
    buffer_load_dwordx4 v[112:115], v2, s[36:39], s27 offen sc1
    buffer_load_dwordx4 v[116:119], v3, s[36:39], s27 offen sc1
    s_add_u32 s25, s25, 4096
    s_cmp_ge_u32 s25, 90112
    s_cselect_b32 s25, s26, s25
    v_mfma_f32_32x32x16_bf16 v[48:63], v[132:135], v[216:219], v[48:63]
    v_mfma_f32_32x32x16_bf16 v[32:47], v[128:131], v[220:223], v[32:47]
    v_mfma_f32_32x32x16_bf16 v[16:31], v[128:131], v[216:219], v[16:31]
    s_waitcnt vmcnt(12)
    v_mfma_f32_32x32x16_bf16 v[64:79], v[140:143], v[92:95], v[64:79]
    s_min_u32 s27, s25, 87040
    buffer_load_dwordx4 v[248:251], v2, s[36:39], s27 offen sc1
    buffer_load_dwordx4 v[252:255], v3, s[36:39], s27 offen sc1
    s_add_u32 s25, s25, 4096
    s_cmp_ge_u32 s25, 90112
    s_cselect_b32 s25, s26, s25
    v_mfma_f32_32x32x16_bf16 v[48:63], v[140:143], v[88:91], v[48:63]
    v_mfma_f32_32x32x16_bf16 v[32:47], v[136:139], v[92:95], v[32:47]
    v_mfma_f32_32x32x16_bf16 v[16:31], v[136:139], v[88:91], v[16:31]
    s_waitcnt vmcnt(12)
    v_mfma_f32_32x32x16_bf16 v[64:79], v[148:151], v[228:231], v[64:79]
    s_min_u32 s27, s25, 87040
    buffer_load_dwordx4 v[120:123], v2, s[36:39], s27 offen sc1
    buffer_load_dwordx4 v[124:127], v3, s[36:39], s27 offen sc1
    s_add_u32 s25, s25, 4096
    s_cmp_ge_u32 s25, 90112
    s_cselect_b32 s25, s26, s25
    v_mfma_f32_32x32x16_bf16 v[48:63], v[148:151], v[224:227], v[48:63]
    v_mfma_f32_32x32x16_bf16 v[32:47], v[144:147], v[228:231], v[32:47]
    v_mfma_f32_32x32x16_bf16 v[16:31], v[144:147], v[224:227], v[16:31]
    s_waitcnt vmcnt(12)
    v_mfma_f32_32x32x16_bf16 v[64:79], v[156:159], v[100:103], v[64:79]
    s_min_u32 s27, s25, 87040
    buffer_load_dwordx4 v[80:83], v2, s[36:39], s27 offen sc1
    buffer_load_dwordx4 v[84:87], v3, s[36:39], s27 offen sc1
    s_add_u32 s25, s25, 4096
    s_cmp_ge_u32 s25, 90112
    s_cselect_b32 s25, s26, s25
    v_mfma_f32_32x32x16_bf16 v[48:63], v[156:159], v[96:99], v[48:63]
    s_mov_b64 exec, 1
    v_mov_b32 v12, 34104
    v_mov_b32 v13, 1
    ds_add_u32 v12, v13
    s_mov_b64 exec, -1
    v_mfma_f32_32x32x16_bf16 v[32:47], v[152:155], v[100:103], v[32:47]
    s_add_u32 s12, s60, 0xc00000
    s_addc_u32 s13, s61, 0
    s_mov_b32 s14, 0x210000
    s_mov_b32 s15, 0x20000
    s_add_u32 s8, s60, 0x1100000
    v_mfma_f32_32x32x16_bf16 v[16:31], v[152:155], v[96:99], v[16:31]
    s_addc_u32 s9, s61, 0
    s_mov_b32 s10, 0x2000
    s_mov_b32 s11, 0x20000
    v_and_b32 v8, 31, v1
    v_lshrrev_b32 v14, 5, v1
    s_lshl_b32 s20, s78, 1
    s_and_b32 s21, s77, 1
    s_add_u32 s20, s20, s21
    s_lshl_b32 s20, s20, 5
    v_add_u32 v10, s20, v8
    s_lshl_b32 s21, s79, 1
    s_lshr_b32 s22, s77, 1
    s_add_u32 s21, s21, s22
    s_mul_i32 s22, s21, 135168
    s_lshl_b32 s21, s21, 6
    v_lshl_add_u32 v11, v14, 5, s21
    v_lshl_add_u32 v7, v10, 10, v11
    v_lshlrev_b32 v10, 2, v10
    buffer_load_dword v128, v10, s[8:11], 0 offen sc1
    s_lshl_b32 s20, s20, 1
    s_add_u32 s22, s22, s20
    v_lshrrev_b32 v10, 2, v1
    v_mul_u32_u24 v10, 4224, v10
    v_and_b32 v11, 3, v1
    v_lshl_add_u32 v10, v11, 4, v10
    v_add_u32 v10, s22, v10
    s_lshl_b32 s20, s77, 11
    s_add_u32 s20, s20, 44032
    v_add_u32 v8, s20, v6
    v_lshlrev_b32 v11, 3, v11
    v_bfe_u32 v216, v1, 4, 1
    v_lshl_add_u32 v11, v216, 5, v11
    v_bfe_u32 v216, v1, 2, 2
    v_lshl_add_u32 v216, v14, 4, v216
    v_lshl_add_u32 v11, v216, 6, v11
    v_add_u32 v11, s20, v11
    s_mov_b32 s8, s56
    s_mov_b32 s9, s57
    s_mov_b32 s10, 0x200000
    s_mov_b32 s11, 0x20000
    s_waitcnt vmcnt(13)
    v_mfma_f32_32x32x16_bf16 v[64:79], v[164:167], v[236:239], v[64:79]
    s_min_u32 s27, s25, 87040
    buffer_load_dwordx4 v[144:147], v2, s[36:39], s27 offen sc1
    buffer_load_dwordx4 v[148:151], v3, s[36:39], s27 offen sc1
    s_add_u32 s25, s25, 4096
    s_cmp_ge_u32 s25, 90112
    s_cselect_b32 s25, s26, s25
    v_mfma_f32_32x32x16_bf16 v[48:63], v[164:167], v[232:235], v[48:63]
    v_mfma_f32_32x32x16_bf16 v[32:47], v[160:163], v[236:239], v[32:47]
    v_mfma_f32_32x32x16_bf16 v[16:31], v[160:163], v[232:235], v[16:31]
    s_waitcnt vmcnt(13)
    v_mfma_f32_32x32x16_bf16 v[64:79], v[172:175], v[108:111], v[64:79]
    s_min_u32 s27, s25, 87040
    buffer_load_dwordx4 v[224:227], v2, s[36:39], s27 offen sc1
    buffer_load_dwordx4 v[228:231], v3, s[36:39], s27 offen sc1
    s_add_u32 s25, s25, 4096
    s_cmp_ge_u32 s25, 90112
    s_cselect_b32 s25, s26, s25
    v_mfma_f32_32x32x16_bf16 v[48:63], v[172:175], v[104:107], v[48:63]
    v_mfma_f32_32x32x16_bf16 v[32:47], v[168:171], v[108:111], v[32:47]
    v_mfma_f32_32x32x16_bf16 v[16:31], v[168:171], v[104:107], v[16:31]
    s_waitcnt vmcnt(13)
    v_mfma_f32_32x32x16_bf16 v[64:79], v[180:183], v[244:247], v[64:79]
    s_min_u32 s27, s25, 87040
    buffer_load_dwordx4 v[152:155], v2, s[36:39], s27 offen sc1
    buffer_load_dwordx4 v[156:159], v3, s[36:39], s27 offen sc1
    s_add_u32 s25, s25, 4096
    s_cmp_ge_u32 s25, 90112
    s_cselect_b32 s25, s26, s25
    v_mfma_f32_32x32x16_bf16 v[48:63], v[180:183], v[240:243], v[48:63]
    v_mfma_f32_32x32x16_bf16 v[32:47], v[176:179], v[244:247], v[32:47]
    v_mfma_f32_32x32x16_bf16 v[16:31], v[176:179], v[240:243], v[16:31]
    s_waitcnt vmcnt(13)
    v_mfma_f32_32x32x16_bf16 v[64:79], v[188:191], v[116:119], v[64:79]
    s_min_u32 s27, s25, 87040
    buffer_load_dwordx4 v[96:99], v2, s[36:39], s27 offen sc1
    buffer_load_dwordx4 v[100:103], v3, s[36:39], s27 offen sc1
    s_add_u32 s25, s25, 4096
    s_cmp_ge_u32 s25, 90112
    s_cselect_b32 s25, s26, s25
    v_mfma_f32_32x32x16_bf16 v[48:63], v[188:191], v[112:115], v[48:63]
    v_mfma_f32_32x32x16_bf16 v[32:47], v[184:187], v[116:119], v[32:47]
    v_mfma_f32_32x32x16_bf16 v[16:31], v[184:187], v[112:115], v[16:31]
    s_waitcnt vmcnt(13)
    v_mfma_f32_32x32x16_bf16 v[64:79], v[196:199], v[252:255], v[64:79]
    s_min_u32 s27, s25, 87040
    buffer_load_dwordx4 v[160:163], v2, s[36:39], s27 offen sc1
    buffer_load_dwordx4 v[164:167], v3, s[36:39], s27 offen sc1
    s_add_u32 s25, s25, 4096
    s_cmp_ge_u32 s25, 90112
    s_cselect_b32 s25, s26, s25
    v_mfma_f32_32x32x16_bf16 v[48:63], v[196:199], v[248:251], v[48:63]
    ds_read_b64_tr_b16 v[232:233], v5 offset:0
    ds_read_b64_tr_b16 v[234:235], v5 offset:1024
    ds_read_b64_tr_b16 v[236:237], v9 offset:0
    ds_read_b64_tr_b16 v[238:239], v9 offset:1024
    buffer_load_dwordx2 v[132:133], v15, s[28:31], s17 offen sc1
    v_mfma_f32_32x32x16_bf16 v[32:47], v[192:195], v[252:255], v[32:47]
    v_mfma_f32_32x32x16_bf16 v[16:31], v[192:195], v[248:251], v[16:31]
    s_waitcnt vmcnt(14)
    v_mfma_f32_32x32x16_bf16 v[64:79], v[204:207], v[124:127], v[64:79]
    ds_read_b64_tr_b16 v[168:169], v5 offset:2048
    ds_read_b64_tr_b16 v[170:171], v5 offset:3072
    ds_read_b64_tr_b16 v[172:173], v9 offset:2048
    ds_read_b64_tr_b16 v[174:175], v9 offset:3072
    v_mfma_f32_32x32x16_bf16 v[48:63], v[204:207], v[120:123], v[48:63]
    v_mfma_f32_32x32x16_bf16 v[32:47], v[200:203], v[124:127], v[32:47]
    v_mfma_f32_32x32x16_bf16 v[16:31], v[200:203], v[120:123], v[16:31]
    s_waitcnt vmcnt(12)
    v_mfma_f32_32x32x16_bf16 v[64:79], v[212:215], v[84:87], v[64:79]
    ds_read_b64_tr_b16 v[104:105], v5 offset:4096
    ds_read_b64_tr_b16 v[106:107], v5 offset:5120
    ds_read_b64_tr_b16 v[108:109], v9 offset:4096
    ds_read_b64_tr_b16 v[110:111], v9 offset:5120
    v_mfma_f32_32x32x16_bf16 v[48:63], v[212:215], v[80:83], v[48:63]
    v_mfma_f32_32x32x16_bf16 v[32:47], v[208:211], v[84:87], v[32:47]
    v_mfma_f32_32x32x16_bf16 v[16:31], v[208:211], v[80:83], v[16:31]
    s_waitcnt vmcnt(9) lgkmcnt(8)
    v_mfma_f32_32x32x16_bf16 v[64:79], v[236:239], v[148:151], v[64:79]
    ds_read_b64_tr_b16 v[176:177], v5 offset:6144
    ds_read_b64_tr_b16 v[178:179], v5 offset:7168
    ds_read_b64_tr_b16 v[180:181], v9 offset:6144
    ds_read_b64_tr_b16 v[182:183], v9 offset:7168
    v_mov_b32 v12, 34104
    v_mfma_f32_32x32x16_bf16 v[48:63], v[236:239], v[144:147], v[48:63]
    ds_read_b32 v13, v12
    v_mfma_f32_32x32x16_bf16 v[32:47], v[232:235], v[148:151], v[32:47]
    v_mfma_f32_32x32x16_bf16 v[16:31], v[232:235], v[144:147], v[16:31]
    s_waitcnt vmcnt(7) lgkmcnt(9)
    v_mfma_f32_32x32x16_bf16 v[64:79], v[172:175], v[228:231], v[64:79]
    ds_read_b64_tr_b16 v[240:241], v5 offset:8192
    ds_read_b64_tr_b16 v[242:243], v5 offset:9216
    ds_read_b64_tr_b16 v[244:245], v9 offset:8192
    ds_read_b64_tr_b16 v[246:247], v9 offset:9216
    v_mfma_f32_32x32x16_bf16 v[48:63], v[172:175], v[224:227], v[48:63]
    v_mfma_f32_32x32x16_bf16 v[32:47], v[168:171], v[228:231], v[32:47]
    v_mfma_f32_32x32x16_bf16 v[16:31], v[168:171], v[224:227], v[16:31]
    s_waitcnt vmcnt(5) lgkmcnt(9)
    v_mfma_f32_32x32x16_bf16 v[64:79], v[108:111], v[156:159], v[64:79]
    s_waitcnt vmcnt(0)
    s_mov_b32 s53, 0
    s_mov_b32 s44, 0
    v_cmp_ne_u64 vcc, s[18:19], v[132:133]
    s_cbranch_vccnz pyno28
    s_mov_b32 s53, 67584
    buffer_load_dwordx4 v[216:219], v10, s[12:15], 0 offen sc1
    buffer_load_dwordx4 v[220:223], v10, s[12:15], s53 offen sc1
pyno28:
    v_mfma_f32_32x32x16_bf16 v[48:63], v[108:111], v[152:155], v[48:63]
    s_waitcnt lgkmcnt(0)
    v_readfirstlane_b32 s22, v13
    s_cmp_ge_u32 s22, 4
    s_cbranch_scc1 own29
    v_mov_b32 v12, 34104
lw30:
    ds_read_b32 v13, v12
    s_waitcnt lgkmcnt(0)
    v_readfirstlane_b32 s22, v13
    s_cmp_ge_u32 s22, 4
    s_cbranch_scc1 lwok30
    s_sub_u32 s101, s101, 1
    s_cmp_lt_i32 s101, 0
    s_cbranch_scc1 lwok30
    s_branch lw30
lwok30:
own29:
    v_mfma_f32_32x32x16_bf16 v[32:47], v[104:107], v[156:159], v[32:47]
    s_xor_b32 s20, s77, 1
    s_mul_i32 s21, s20, 12288
    s_cmp_eq_u32 s20, 3
    s_cselect_b32 s21, -23808, s21
    s_add_u32 s21, s21, 76032
    v_mfma_f32_32x32x16_bf16 v[16:31], v[104:107], v[152:155], v[16:31]
    v_add_u32 v2, s21, v6
    s_xor_b32 s20, s77, 2
    s_mul_i32 s21, s20, 12288
    s_cmp_eq_u32 s20, 3
    s_cselect_b32 s21, -23808, s21
    s_add_u32 s21, s21, 80128
    v_add_u32 v3, s21, v6
    s_xor_b32 s20, s77, 3
    s_mul_i32 s21, s20, 12288
    s_cmp_eq_u32 s20, 3
    s_cselect_b32 s21, -23808, s21
    s_add_u32 s21, s21, 84224
    v_add_u32 v4, s21, v6
    s_mul_i32 s20, s77, 12288
    s_cmp_eq_u32 s77, 3
    s_cselect_b32 s20, -23808, s20
    s_add_u32 s20, s20, 76032
    v_add_u32 v14, s20, v6
    v_mfma_f32_32x32x16_bf16 v[64:79], v[180:183], v[100:103], v[64:79]
    v_mfma_f32_32x32x16_bf16 v[48:63], v[180:183], v[96:99], v[48:63]
    v_mfma_f32_32x32x16_bf16 v[32:47], v[176:179], v[100:103], v[32:47]
    v_mfma_f32_32x32x16_bf16 v[16:31], v[176:179], v[96:99], v[16:31]
    v_mfma_f32_32x32x16_bf16 v[64:79], v[244:247], v[164:167], v[64:79]
    v_mfma_f32_32x32x16_bf16 v[48:63], v[244:247], v[160:163], v[48:63]
    v_mfma_f32_32x32x16_bf16 v[32:47], v[240:243], v[164:167], v[32:47]
    v_mfma_f32_32x32x16_bf16 v[16:31], v[240:243], v[160:163], v[16:31]
    s_nop 8
    ds_write_b128 v4, v[64:67] offset:0
    ds_write_b128 v4, v[68:71] offset:1024
    ds_write_b128 v4, v[72:75] offset:2048
    ds_write_b128 v4, v[76:79] offset:3072
    ds_write_b128 v3, v[48:51] offset:0
    ds_write_b128 v3, v[52:55] offset:1024
    ds_write_b128 v3, v[56:59] offset:2048
    ds_write_b128 v3, v[60:63] offset:3072
    ds_write_b128 v2, v[32:35] offset:0
    ds_write_b128 v2, v[36:39] offset:1024
    ds_write_b128 v2, v[40:43] offset:2048
    ds_write_b128 v2, v[44:47] offset:3072
    v_mov_b32 v129, v128
    v_sub_f32 v130, 1.0, v128
    v_sub_f32 v131, 1.0, v128
    s_waitcnt lgkmcnt(0)
    s_barrier
    ds_read_b128 v[184:187], v14 offset:0
    ds_read_b128 v[188:191], v14 offset:1024
    ds_read_b128 v[112:115], v14 offset:2048
    ds_read_b128 v[116:119], v14 offset:3072
    ds_read_b128 v[192:195], v14 offset:4096
    ds_read_b128 v[196:199], v14 offset:5120
    ds_read_b128 v[248:251], v14 offset:6144
    ds_read_b128 v[252:255], v14 offset:7168
    ds_read_b128 v[200:203], v14 offset:8192
    ds_read_b128 v[204:207], v14 offset:9216
    ds_read_b128 v[120:123], v14 offset:10240
    ds_read_b128 v[124:127], v14 offset:11264
    s_cmp_lg_u32 s53, 0
    s_cbranch_scc1 pys31
py31:
    buffer_load_dwordx2 v[132:133], v15, s[28:31], s17 offen sc1
    s_waitcnt vmcnt(0)
    v_cmp_ne_u64 vcc, s[18:19], v[132:133]
    s_cbranch_vccz pyl31
    s_sub_u32 s101, s101, 1
    s_cmp_lt_i32 s101, 0
    s_cbranch_scc1 pyl31
    s_branch py31
pyl31:
    s_mov_b32 s53, 67584
    buffer_load_dwordx4 v[216:219], v10, s[12:15], 0 offen sc1
    buffer_load_dwordx4 v[220:223], v10, s[12:15], s53 offen sc1
pys31:
    s_waitcnt vmcnt(0)
    ds_write_b128 v8, v[216:219]
    ds_write_b128 v8, v[220:223] offset:1024
    ds_read_b64_tr_b16 v[216:217], v11 offset:0
    ds_read_b64_tr_b16 v[218:219], v11 offset:256
    ds_read_b64_tr_b16 v[220:221], v11 offset:512
    ds_read_b64_tr_b16 v[222:223], v11 offset:768
    s_waitcnt lgkmcnt(14)
    v_pk_add_f32 v[16:17], v[16:17], v[184:185]
    v_pk_add_f32 v[18:19], v[18:19], v[186:187]
    v_pk_add_f32 v[20:21], v[20:21], v[188:189]
    v_pk_add_f32 v[22:23], v[22:23], v[190:191]
    v_pk_add_f32 v[24:25], v[24:25], v[112:113]
    v_pk_add_f32 v[26:27], v[26:27], v[114:115]
    v_pk_add_f32 v[28:29], v[28:29], v[116:117]
    v_pk_add_f32 v[30:31], v[30:31], v[118:119]
    s_waitcnt lgkmcnt(6)
    v_pk_add_f32 v[192:193], v[192:193], v[200:201]
    v_pk_add_f32 v[194:195], v[194:195], v[202:203]
    v_pk_add_f32 v[196:197], v[196:197], v[204:205]
    v_pk_add_f32 v[198:199], v[198:199], v[206:207]
    v_pk_add_f32 v[248:249], v[248:249], v[120:121]
    v_pk_add_f32 v[250:251], v[250:251], v[122:123]
    v_pk_add_f32 v[252:253], v[252:253], v[124:125]
    v_pk_add_f32 v[254:255], v[254:255], v[126:127]
    s_waitcnt lgkmcnt(0)
    v_lshlrev_b32 v136, 16, v216
    v_and_b32 v137, 0xffff0000, v216
    v_lshlrev_b32 v138, 16, v217
    v_and_b32 v139, 0xffff0000, v217
    v_lshlrev_b32 v140, 16, v218
    v_and_b32 v141, 0xffff0000, v218
    v_lshlrev_b32 v142, 16, v219
    v_and_b32 v143, 0xffff0000, v219
    v_lshlrev_b32 v88, 16, v220
    v_and_b32 v89, 0xffff0000, v220
    v_lshlrev_b32 v90, 16, v221
    v_and_b32 v91, 0xffff0000, v221
    v_lshlrev_b32 v92, 16, v222
    v_and_b32 v93, 0xffff0000, v222
    v_lshlrev_b32 v94, 16, v223
    v_and_b32 v95, 0xffff0000, v223
    v_pk_mul_f32 v[136:137], v[136:137], v[128:129]
    v_pk_mul_f32 v[138:139], v[138:139], v[128:129]
    v_pk_mul_f32 v[140:141], v[140:141], v[128:129]
    v_pk_mul_f32 v[142:143], v[142:143], v[128:129]
    v_pk_mul_f32 v[88:89], v[88:89], v[128:129]
    v_pk_mul_f32 v[90:91], v[90:91], v[128:129]
    v_pk_mul_f32 v[92:93], v[92:93], v[128:129]
    v_pk_mul_f32 v[94:95], v[94:95], v[128:129]
    v_pk_add_f32 v[16:17], v[16:17], v[192:193]
    v_pk_add_f32 v[18:19], v[18:19], v[194:195]
    v_pk_add_f32 v[20:21], v[20:21], v[196:197]
    v_pk_add_f32 v[22:23], v[22:23], v[198:199]
    v_pk_fma_f32 v[136:137], v[16:17], v[130:131], v[136:137]
    v_pk_fma_f32 v[138:139], v[18:19], v[130:131], v[138:139]
    v_pk_fma_f32 v[140:141], v[20:21], v[130:131], v[140:141]
    v_pk_fma_f32 v[142:143], v[22:23], v[130:131], v[142:143]
    v_cvt_pk_bf16_f32 v32, v136, v137
    v_cvt_pk_bf16_f32 v33, v138, v139
    v_cvt_pk_bf16_f32 v34, v140, v141
    v_cvt_pk_bf16_f32 v35, v142, v143
    buffer_store_dwordx4 v[32:35], v7, s[8:11], 0 offen offset:0
    v_pk_add_f32 v[24:25], v[24:25], v[248:249]
    v_pk_add_f32 v[26:27], v[26:27], v[250:251]
    v_pk_add_f32 v[28:29], v[28:29], v[252:253]
    v_pk_add_f32 v[30:31], v[30:31], v[254:255]
    v_pk_fma_f32 v[88:89], v[24:25], v[130:131], v[88:89]
    v_pk_fma_f32 v[90:91], v[26:27], v[130:131], v[90:91]
    v_pk_fma_f32 v[92:93], v[28:29], v[130:131], v[92:93]
    v_pk_fma_f32 v[94:95], v[30:31], v[130:131], v[94:95]
    v_cvt_pk_bf16_f32 v36, v88, v89
    v_cvt_pk_bf16_f32 v37, v90, v91
    v_cvt_pk_bf16_f32 v38, v92, v93
    v_cvt_pk_bf16_f32 v39, v94, v95
    buffer_store_dwordx4 v[36:39], v7, s[8:11], 0 offen offset:16
    s_endpgm
A_gate:
    v_and_b32 v2, 31, v1
    v_lshrrev_b32 v3, 5, v1
    v_bfe_u32 v4, v1, 1, 3
    s_lshl_b32 s69, s67, 13
    s_add_u32 s69, s69, 34816
    v_lshlrev_b32 v5, 7, v2
    v_add_u32 v5, s69, v5
    v_or_b32 v6, 0, v3
    v_xor_b32 v6, v6, v4
    v_lshl_add_u32 v152, v6, 4, v5
    v_add_u32 v156, 41216, v152
    v_add_u32 v160, 82432, v152
    v_or_b32 v6, 2, v3
    v_xor_b32 v6, v6, v4
    v_lshl_add_u32 v153, v6, 4, v5
    v_add_u32 v157, 41216, v153
    v_add_u32 v161, 82432, v153
    v_or_b32 v6, 4, v3
    v_xor_b32 v6, v6, v4
    v_lshl_add_u32 v154, v6, 4, v5
    v_add_u32 v158, 41216, v154
    v_add_u32 v162, 82432, v154
    v_or_b32 v6, 6, v3
    v_xor_b32 v6, v6, v4
    v_lshl_add_u32 v155, v6, 4, v5
    v_add_u32 v159, 41216, v155
    v_add_u32 v163, 82432, v155
    s_mov_b32 s16, s54
    s_mov_b32 s17, s55
    s_mov_b32 s18, 0x400
    s_mov_b32 s19, 0x20000
    v_lshlrev_b32 v14, 4, v3
    s_add_u32 s75, s76, 0
    s_and_b32 s75, s75, 7
    s_lshl_b32 s75, s75, 7
    buffer_load_dwordx4 v[16:19], v14, s[16:19], s75 offen offset:0
    buffer_load_dwordx4 v[20:23], v14, s[16:19], s75 offen offset:32
    buffer_load_dwordx4 v[24:27], v14, s[16:19], s75 offen offset:64
    buffer_load_dwordx4 v[28:31], v14, s[16:19], s75 offen offset:96
    s_add_u32 s75, s76, 1
    s_and_b32 s75, s75, 7
    s_lshl_b32 s75, s75, 7
    buffer_load_dwordx4 v[32:35], v14, s[16:19], s75 offen offset:0
    buffer_load_dwordx4 v[36:39], v14, s[16:19], s75 offen offset:32
    buffer_load_dwordx4 v[40:43], v14, s[16:19], s75 offen offset:64
    buffer_load_dwordx4 v[44:47], v14, s[16:19], s75 offen offset:96
    s_add_u32 s75, s76, 2
    s_and_b32 s75, s75, 7
    s_lshl_b32 s75, s75, 7
    buffer_load_dwordx4 v[48:51], v14, s[16:19], s75 offen offset:0
    buffer_load_dwordx4 v[52:55], v14, s[16:19], s75 offen offset:32
    buffer_load_dwordx4 v[56:59], v14, s[16:19], s75 offen offset:64
    buffer_load_dwordx4 v[60:63], v14, s[16:19], s75 offen offset:96
    s_add_u32 s75, s76, 3
    s_and_b32 s75, s75, 7
    s_lshl_b32 s75, s75, 7
    buffer_load_dwordx4 v[64:67], v14, s[16:19], s75 offen offset:0
    buffer_load_dwordx4 v[68:71], v14, s[16:19], s75 offen offset:32
    buffer_load_dwordx4 v[72:75], v14, s[16:19], s75 offen offset:64
    buffer_load_dwordx4 v[76:79], v14, s[16:19], s75 offen offset:96
    s_add_u32 s75, s76, 4
    s_and_b32 s75, s75, 7
    s_lshl_b32 s75, s75, 7
    buffer_load_dwordx4 v[80:83], v14, s[16:19], s75 offen offset:0
    buffer_load_dwordx4 v[84:87], v14, s[16:19], s75 offen offset:32
    buffer_load_dwordx4 v[88:91], v14, s[16:19], s75 offen offset:64
    buffer_load_dwordx4 v[92:95], v14, s[16:19], s75 offen offset:96
    s_add_u32 s75, s76, 5
    s_and_b32 s75, s75, 7
    s_lshl_b32 s75, s75, 7
    buffer_load_dwordx4 v[96:99], v14, s[16:19], s75 offen offset:0
    buffer_load_dwordx4 v[100:103], v14, s[16:19], s75 offen offset:32
    buffer_load_dwordx4 v[104:107], v14, s[16:19], s75 offen offset:64
    buffer_load_dwordx4 v[108:111], v14, s[16:19], s75 offen offset:96
    s_add_u32 s75, s76, 6
    s_and_b32 s75, s75, 7
    s_lshl_b32 s75, s75, 7
    buffer_load_dwordx4 v[112:115], v14, s[16:19], s75 offen offset:0
    buffer_load_dwordx4 v[116:119], v14, s[16:19], s75 offen offset:32
    buffer_load_dwordx4 v[120:123], v14, s[16:19], s75 offen offset:64
    buffer_load_dwordx4 v[124:127], v14, s[16:19], s75 offen offset:96
    s_add_u32 s75, s76, 7
    s_and_b32 s75, s75, 7
    s_lshl_b32 s75, s75, 7
    buffer_load_dwordx4 v[128:131], v14, s[16:19], s75 offen offset:0
    buffer_load_dwordx4 v[132:135], v14, s[16:19], s75 offen offset:32
    buffer_load_dwordx4 v[136:139], v14, s[16:19], s75 offen offset:64
    buffer_load_dwordx4 v[140:143], v14, s[16:19], s75 offen offset:96
    s_add_u32 s74, s76, 1
    s_and_b32 s74, s74, 7
    s_mul_i32 s75, s74, 176128
    s_lshl_b32 s74, s74, 7
    s_add_u32 m0, s72, 76032
    s_nop 0
    buffer_load_dwordx4 v236, s[4:7], s74 offen lds
    s_add_u32 m0, s72, 77056
    s_nop 0
    buffer_load_dwordx4 v237, s[4:7], s74 offen lds
    s_add_u32 m0, s72, 78080
    s_nop 0
    buffer_load_dwordx4 v238, s[4:7], s74 offen lds
    s_add_u32 m0, s72, 79104
    s_nop 0
    buffer_load_dwordx4 v239, s[4:7], s74 offen lds
    s_add_u32 m0, s73, 76032
    s_nop 0
    buffer_load_dwordx4 v240, s[8:11], s75 offen lds
    s_add_u32 m0, s73, 88352
    s_nop 0
    buffer_load_dwordx4 v240, s[12:15], s75 offen lds
    s_add_u32 m0, s73, 77056
    s_nop 0
    buffer_load_dwordx4 v241, s[8:11], s75 offen lds
    s_add_u32 m0, s73, 89376
    s_nop 0
    buffer_load_dwordx4 v241, s[12:15], s75 offen lds
    s_add_u32 m0, s73, 78080
    s_nop 0
    buffer_load_dwordx4 v242, s[8:11], s75 offen lds
    s_add_u32 m0, s73, 90400
    s_nop 0
    buffer_load_dwordx4 v242, s[12:15], s75 offen lds
    s_waitcnt vmcnt(10)
    s_barrier
    ds_read_b128 v[164:167], v152 offset:0
    ds_read_b128 v[168:171], v152 offset:4096
    ds_read_b128 v[172:175], v153 offset:0
    ds_read_b128 v[176:179], v153 offset:4096
    ds_read_b128 v[180:183], v154 offset:0
    ds_read_b128 v[184:187], v154 offset:4096
    ds_read_b128 v[188:191], v155 offset:0
    ds_read_b128 v[192:195], v155 offset:4096
    s_waitcnt lgkmcnt(0)
    v_mfma_f32_32x32x16_bf16 v[222:237], v[16:19], v[164:167], 0
    v_mfma_f32_32x32x16_bf16 v[238:253], v[16:19], v[168:171], 0
    v_mfma_f32_32x32x16_bf16 v[222:237], v[20:23], v[172:175], v[222:237]
    v_mfma_f32_32x32x16_bf16 v[238:253], v[20:23], v[176:179], v[238:253]
    v_mfma_f32_32x32x16_bf16 v[222:237], v[24:27], v[180:183], v[222:237]
    v_mfma_f32_32x32x16_bf16 v[238:253], v[24:27], v[184:187], v[238:253]
    v_mfma_f32_32x32x16_bf16 v[222:237], v[28:31], v[188:191], v[222:237]
    v_mfma_f32_32x32x16_bf16 v[238:253], v[28:31], v[192:195], v[238:253]
    s_waitcnt vmcnt(0)
    s_barrier
    ds_read_b128 v[164:167], v156 offset:0
    ds_read_b128 v[168:171], v156 offset:4096
    ds_read_b128 v[172:175], v157 offset:0
    ds_read_b128 v[176:179], v157 offset:4096
    ds_read_b128 v[180:183], v158 offset:0
    ds_read_b128 v[184:187], v158 offset:4096
    ds_read_b128 v[188:191], v159 offset:0
    ds_read_b128 v[192:195], v159 offset:4096
    s_waitcnt lgkmcnt(0)
    v_mfma_f32_32x32x16_bf16 v[222:237], v[32:35], v[164:167], v[222:237]
    v_mfma_f32_32x32x16_bf16 v[238:253], v[32:35], v[168:171], v[238:253]
    v_mfma_f32_32x32x16_bf16 v[222:237], v[36:39], v[172:175], v[222:237]
    v_mfma_f32_32x32x16_bf16 v[238:253], v[36:39], v[176:179], v[238:253]
    v_mfma_f32_32x32x16_bf16 v[222:237], v[40:43], v[180:183], v[222:237]
    v_mfma_f32_32x32x16_bf16 v[238:253], v[40:43], v[184:187], v[238:253]
    v_mfma_f32_32x32x16_bf16 v[222:237], v[44:47], v[188:191], v[222:237]
    v_mfma_f32_32x32x16_bf16 v[238:253], v[44:47], v[192:195], v[238:253]
    s_barrier
    ds_read_b128 v[164:167], v160 offset:0
    ds_read_b128 v[168:171], v160 offset:4096
    ds_read_b128 v[172:175], v161 offset:0
    ds_read_b128 v[176:179], v161 offset:4096
    ds_read_b128 v[180:183], v162 offset:0
    ds_read_b128 v[184:187], v162 offset:4096
    ds_read_b128 v[188:191], v163 offset:0
    ds_read_b128 v[192:195], v163 offset:4096
    s_waitcnt lgkmcnt(0)
    v_mfma_f32_32x32x16_bf16 v[222:237], v[48:51], v[164:167], v[222:237]
    v_mfma_f32_32x32x16_bf16 v[238:253], v[48:51], v[168:171], v[238:253]
    v_mfma_f32_32x32x16_bf16 v[222:237], v[52:55], v[172:175], v[222:237]
    v_mfma_f32_32x32x16_bf16 v[238:253], v[52:55], v[176:179], v[238:253]
    v_mfma_f32_32x32x16_bf16 v[222:237], v[56:59], v[180:183], v[222:237]
    v_mfma_f32_32x32x16_bf16 v[238:253], v[56:59], v[184:187], v[238:253]
    v_mfma_f32_32x32x16_bf16 v[222:237], v[60:63], v[188:191], v[222:237]
    v_mfma_f32_32x32x16_bf16 v[238:253], v[60:63], v[192:195], v[238:253]
    s_barrier
    ds_read_b128 v[164:167], v152 offset:0
    ds_read_b128 v[168:171], v152 offset:4096
    ds_read_b128 v[172:175], v153 offset:0
    ds_read_b128 v[176:179], v153 offset:4096
    ds_read_b128 v[180:183], v154 offset:0
    ds_read_b128 v[184:187], v154 offset:4096
    ds_read_b128 v[188:191], v155 offset:0
    ds_read_b128 v[192:195], v155 offset:4096
    s_waitcnt lgkmcnt(0)
    v_mfma_f32_32x32x16_bf16 v[222:237], v[64:67], v[164:167], v[222:237]
    v_mfma_f32_32x32x16_bf16 v[238:253], v[64:67], v[168:171], v[238:253]
    v_mfma_f32_32x32x16_bf16 v[222:237], v[68:71], v[172:175], v[222:237]
    v_mfma_f32_32x32x16_bf16 v[238:253], v[68:71], v[176:179], v[238:253]
    v_mfma_f32_32x32x16_bf16 v[222:237], v[72:75], v[180:183], v[222:237]
    v_mfma_f32_32x32x16_bf16 v[238:253], v[72:75], v[184:187], v[238:253]
    v_mfma_f32_32x32x16_bf16 v[222:237], v[76:79], v[188:191], v[222:237]
    v_mfma_f32_32x32x16_bf16 v[238:253], v[76:79], v[192:195], v[238:253]
    s_barrier
    ds_read_b128 v[164:167], v156 offset:0
    ds_read_b128 v[168:171], v156 offset:4096
    ds_read_b128 v[172:175], v157 offset:0
    ds_read_b128 v[176:179], v157 offset:4096
    ds_read_b128 v[180:183], v158 offset:0
    ds_read_b128 v[184:187], v158 offset:4096
    ds_read_b128 v[188:191], v159 offset:0
    ds_read_b128 v[192:195], v159 offset:4096
    s_waitcnt lgkmcnt(0)
    v_mfma_f32_32x32x16_bf16 v[222:237], v[80:83], v[164:167], v[222:237]
    v_mfma_f32_32x32x16_bf16 v[238:253], v[80:83], v[168:171], v[238:253]
    v_mfma_f32_32x32x16_bf16 v[222:237], v[84:87], v[172:175], v[222:237]
    v_mfma_f32_32x32x16_bf16 v[238:253], v[84:87], v[176:179], v[238:253]
    v_mfma_f32_32x32x16_bf16 v[222:237], v[88:91], v[180:183], v[222:237]
    v_mfma_f32_32x32x16_bf16 v[238:253], v[88:91], v[184:187], v[238:253]
    v_mfma_f32_32x32x16_bf16 v[222:237], v[92:95], v[188:191], v[222:237]
    v_mfma_f32_32x32x16_bf16 v[238:253], v[92:95], v[192:195], v[238:253]
    s_barrier
    ds_read_b128 v[164:167], v160 offset:0
    ds_read_b128 v[168:171], v160 offset:4096
    ds_read_b128 v[172:175], v161 offset:0
    ds_read_b128 v[176:179], v161 offset:4096
    ds_read_b128 v[180:183], v162 offset:0
    ds_read_b128 v[184:187], v162 offset:4096
    ds_read_b128 v[188:191], v163 offset:0
    ds_read_b128 v[192:195], v163 offset:4096
    s_waitcnt lgkmcnt(0)
    v_mfma_f32_32x32x16_bf16 v[222:237], v[96:99], v[164:167], v[222:237]
    v_mfma_f32_32x32x16_bf16 v[238:253], v[96:99], v[168:171], v[238:253]
    v_mfma_f32_32x32x16_bf16 v[222:237], v[100:103], v[172:175], v[222:237]
    v_mfma_f32_32x32x16_bf16 v[238:253], v[100:103], v[176:179], v[238:253]
    v_mfma_f32_32x32x16_bf16 v[222:237], v[104:107], v[180:183], v[222:237]
    v_mfma_f32_32x32x16_bf16 v[238:253], v[104:107], v[184:187], v[238:253]
    v_mfma_f32_32x32x16_bf16 v[222:237], v[108:111], v[188:191], v[222:237]
    v_mfma_f32_32x32x16_bf16 v[238:253], v[108:111], v[192:195], v[238:253]
    s_barrier
    ds_read_b128 v[164:167], v152 offset:0
    ds_read_b128 v[168:171], v152 offset:4096
    ds_read_b128 v[172:175], v153 offset:0
    ds_read_b128 v[176:179], v153 offset:4096
    ds_read_b128 v[180:183], v154 offset:0
    ds_read_b128 v[184:187], v154 offset:4096
    ds_read_b128 v[188:191], v155 offset:0
    ds_read_b128 v[192:195], v155 offset:4096
    s_waitcnt lgkmcnt(0)
    v_mfma_f32_32x32x16_bf16 v[222:237], v[112:115], v[164:167], v[222:237]
    v_mfma_f32_32x32x16_bf16 v[238:253], v[112:115], v[168:171], v[238:253]
    v_mfma_f32_32x32x16_bf16 v[222:237], v[116:119], v[172:175], v[222:237]
    v_mfma_f32_32x32x16_bf16 v[238:253], v[116:119], v[176:179], v[238:253]
    v_mfma_f32_32x32x16_bf16 v[222:237], v[120:123], v[180:183], v[222:237]
    v_mfma_f32_32x32x16_bf16 v[238:253], v[120:123], v[184:187], v[238:253]
    v_mfma_f32_32x32x16_bf16 v[222:237], v[124:127], v[188:191], v[222:237]
    v_mfma_f32_32x32x16_bf16 v[238:253], v[124:127], v[192:195], v[238:253]
    s_mov_b64 exec, 1
    v_mov_b32 v12, 34088
    v_mov_b32 v13, 1
    ds_add_u32 v12, v13
    s_mov_b64 exec, -1
    v_mov_b32 v12, 34080
    ds_read_b64 v[10:11], v12
    v_mov_b32 v12, 34092
lw15:
    ds_read_b32 v13, v12
    s_waitcnt lgkmcnt(0)
    v_readfirstlane_b32 s22, v13
    s_cmp_ge_u32 s22, 2
    s_cbranch_scc1 lwok15
    s_sub_u32 s101, s101, 1
    s_cmp_lt_i32 s101, 0
    s_cbranch_scc1 lwok15
    s_branch lw15
lwok15:
    v_readfirstlane_b32 s30, v10
    v_readfirstlane_b32 s31, v11
    s_add_u32 s12, s60, 0x1120000
    s_addc_u32 s13, s61, 0
    s_mov_b32 s14, 0x3a080
    s_mov_b32 s15, 0x20000
    ds_read_b128 v[164:167], v156 offset:0
    ds_read_b128 v[168:171], v156 offset:4096
    ds_read_b128 v[172:175], v157 offset:0
    ds_read_b128 v[176:179], v157 offset:4096
    ds_read_b128 v[180:183], v158 offset:0
    ds_read_b128 v[184:187], v158 offset:4096
    ds_read_b128 v[188:191], v159 offset:0
    ds_read_b128 v[192:195], v159 offset:4096
    s_waitcnt lgkmcnt(0)
    v_mfma_f32_32x32x16_bf16 v[222:237], v[128:131], v[164:167], v[222:237]
    v_mfma_f32_32x32x16_bf16 v[238:253], v[128:131], v[168:171], v[238:253]
    v_mfma_f32_32x32x16_bf16 v[222:237], v[132:135], v[172:175], v[222:237]
    v_mfma_f32_32x32x16_bf16 v[238:253], v[132:135], v[176:179], v[238:253]
    v_mfma_f32_32x32x16_bf16 v[222:237], v[136:139], v[180:183], v[222:237]
    v_mfma_f32_32x32x16_bf16 v[238:253], v[136:139], v[184:187], v[238:253]
    v_mfma_f32_32x32x16_bf16 v[222:237], v[140:143], v[188:191], v[222:237]
    v_mfma_f32_32x32x16_bf16 v[238:253], v[140:143], v[192:195], v[238:253]
    s_add_u32 s16, s60, 0x1100000
    s_addc_u32 s17, s61, 0
    s_mov_b32 s18, 0x2000
    s_mov_b32 s19, 0x20000
    v_lshlrev_b32 v11, 2, v2
    s_lshl_b32 s70, s64, 9
    s_lshl_b32 s71, s67, 8
    s_add_u32 s70, s70, s71
    s_nop 2
    v_cvt_pk_bf16_f32 v12, v222, v222
    v_and_b32 v12, 0xffff0000, v12
    v_mul_f32 v12, 0xbfb8aa3b, v12
    v_exp_f32 v12, v12
    s_nop 0
    v_add_f32 v12, 1.0, v12
    v_rcp_f32 v12, v12
    s_nop 0
    v_cvt_pk_bf16_f32 v12, v12, v12
    v_and_b32 v6, 0xffff0000, v12
    buffer_store_dword v6, v11, s[16:19], s70 offen offset:0 sc1
    v_cvt_pk_bf16_f32 v12, v238, v238
    v_and_b32 v12, 0xffff0000, v12
    v_mul_f32 v12, 0xbfb8aa3b, v12
    v_exp_f32 v12, v12
    s_nop 0
    v_add_f32 v12, 1.0, v12
    v_rcp_f32 v12, v12
    s_nop 0
    v_cvt_pk_bf16_f32 v12, v12, v12
    v_and_b32 v7, 0xffff0000, v12
    buffer_store_dword v7, v11, s[16:19], s70 offen offset:128 sc1
    s_branch A_post
A_idle:
    s_add_u32 s74, s76, 1
    s_and_b32 s74, s74, 7
    s_mul_i32 s75, s74, 176128
    s_lshl_b32 s74, s74, 7
    s_add_u32 m0, s72, 76032
    s_nop 0
    buffer_load_dwordx4 v236, s[4:7], s74 offen lds
    s_add_u32 m0, s72, 77056
    s_nop 0
    buffer_load_dwordx4 v237, s[4:7], s74 offen lds
    s_add_u32 m0, s72, 78080
    s_nop 0
    buffer_load_dwordx4 v238, s[4:7], s74 offen lds
    s_add_u32 m0, s72, 79104
    s_nop 0
    buffer_load_dwordx4 v239, s[4:7], s74 offen lds
    s_add_u32 m0, s73, 76032
    s_nop 0
    buffer_load_dwordx4 v240, s[8:11], s75 offen lds
    s_add_u32 m0, s73, 88352
    s_nop 0
    buffer_load_dwordx4 v240, s[12:15], s75 offen lds
    s_add_u32 m0, s73, 77056
    s_nop 0
    buffer_load_dwordx4 v241, s[8:11], s75 offen lds
    s_add_u32 m0, s73, 89376
    s_nop 0
    buffer_load_dwordx4 v241, s[12:15], s75 offen lds
    s_add_u32 m0, s73, 78080
    s_nop 0
    buffer_load_dwordx4 v242, s[8:11], s75 offen lds
    s_add_u32 m0, s73, 90400
    s_nop 0
    buffer_load_dwordx4 v242, s[12:15], s75 offen lds
    s_mov_b32 s16, s52
    s_mov_b32 s17, s53
    s_mov_b32 s18, 0x158000
    s_mov_b32 s19, 0x20000
    s_and_b32 s20, s63, 1
    s_lshl_b32 s20, s20, 2
    s_add_u32 s20, s20, s77
    v_lshlrev_b32 v2, 10, v1
    s_lshr_b32 s21, s52, 7
    s_sub_u32 s21, 3, s21
    s_and_b32 s21, s21, 7
    s_lshl_b32 s21, s21, 7
    s_mul_i32 s22, s20, 196608
    s_add_u32 s21, s21, s22
    buffer_load_dword v20, v2, s[16:19], s21 offen
    s_add_u32 s21, s21, 65536
    buffer_load_dword v21, v2, s[16:19], s21 offen
    s_add_u32 s21, s21, 65536
    buffer_load_dword v22, v2, s[16:19], s21 offen
    s_add_u32 s21, s21, 65536
    s_waitcnt vmcnt(3)
    s_barrier
    s_barrier
    s_barrier
    s_barrier
    s_barrier
    s_barrier
    s_waitcnt vmcnt(0)
    s_barrier
    s_mov_b64 exec, 1
    v_mov_b32 v12, 34088
    v_mov_b32 v13, 1
    ds_add_u32 v12, v13
    s_mov_b64 exec, -1
    v_mov_b32 v12, 34080
    ds_read_b64 v[10:11], v12
    v_mov_b32 v12, 34092
lw16:
    ds_read_b32 v13, v12
    s_waitcnt lgkmcnt(0)
    v_readfirstlane_b32 s22, v13
    s_cmp_ge_u32 s22, 2
    s_cbranch_scc1 lwok16
    s_sub_u32 s101, s101, 1
    s_cmp_lt_i32 s101, 0
    s_cbranch_scc1 lwok16
    s_branch lw16
lwok16:
    v_readfirstlane_b32 s30, v10
    v_readfirstlane_b32 s31, v11
    s_add_u32 s12, s60, 0x1120000
    s_addc_u32 s13, s61, 0
    s_mov_b32 s14, 0x3a080
    s_mov_b32 s15, 0x20000
    s_branch A_post
dotag1:
    s_add_u32 s28, s60, 0x1120000
    s_addc_u32 s29, s61, 0
    s_mov_b32 s30, 0x3a080
    s_mov_b32 s31, 0x20000
    v_mov_b32 v2, 0
    s_mov_b64 exec, 1
    buffer_load_dwordx2 v[4:5], v2, s[28:31], 0 offen sc1
    s_waitcnt vmcnt(0)
    v_add_co_u32 v4, vcc, 1, v4
    s_nop 1
    v_addc_co_u32 v5, vcc, 0, v5, vcc
    v_or_b32 v5, 0x40000000, v5
    global_store_dwordx2 v2, v[4:5], s[58:59] sc1
    buffer_store_dwordx2 v[4:5], v2, s[28:31], 0 offen sc1
    s_waitcnt vmcnt(0)
    s_mov_b64 exec, -1
    s_branch notag1
mask2:
    s_sub_u32 s71, 15, s65
    s_lshl_b32 s71, s71, 2
    v_mov_b32 v4, 0x40000000
    v_add_u32 v5, 0, v2
    v_mul_u32_u24 v6, s70, v5
    v_lshrrev_b32 v6, 19, v6
    v_mul_u32_u24 v6, 12, v6
    v_sub_u32 v6, v5, v6
    v_cmp_le_u32 vcc, s71, v6
    s_nop 1
    v_cndmask_b32 v6, 0, v4, vcc
    v_add_u32 v240, v6, v240
    v_add_u32 v5, 64, v2
    v_mul_u32_u24 v6, s70, v5
    v_lshrrev_b32 v6, 19, v6
    v_mul_u32_u24 v6, 12, v6
    v_sub_u32 v6, v5, v6
    v_cmp_le_u32 vcc, s71, v6
    s_nop 1
    v_cndmask_b32 v6, 0, v4, vcc
    v_add_u32 v241, v6, v241
    v_add_u32 v5, 128, v2
    v_mul_u32_u24 v6, s70, v5
    v_lshrrev_b32 v6, 19, v6
    v_mul_u32_u24 v6, 12, v6
    v_sub_u32 v6, v5, v6
    v_cmp_le_u32 vcc, s71, v6
    s_nop 1
    v_cndmask_b32 v6, 0, v4, vcc
    v_add_u32 v242, v6, v242
    s_branch nomask2
mask17:
    s_sub_u32 s71, 15, s65
    s_lshl_b32 s71, s71, 2
    v_mov_b32 v4, 0x40000000
    v_add_u32 v5, 0, v2
    v_mul_u32_u24 v6, s70, v5
    v_lshrrev_b32 v6, 19, v6
    v_mul_u32_u24 v6, 12, v6
    v_sub_u32 v6, v5, v6
    v_cmp_le_u32 vcc, s71, v6
    s_nop 1
    v_cndmask_b32 v6, 0, v4, vcc
    v_add_u32 v240, v6, v240
    v_add_u32 v5, 64, v2
    v_mul_u32_u24 v6, s70, v5
    v_lshrrev_b32 v6, 19, v6
    v_mul_u32_u24 v6, 12, v6
    v_sub_u32 v6, v5, v6
    v_cmp_le_u32 vcc, s71, v6
    s_nop 1
    v_cndmask_b32 v6, 0, v4, vcc
    v_add_u32 v241, v6, v241
    v_add_u32 v5, 128, v2
    v_mul_u32_u24 v6, s70, v5
    v_lshrrev_b32 v6, 19, v6
    v_mul_u32_u24 v6, 12, v6
    v_sub_u32 v6, v5, v6
    v_cmp_le_u32 vcc, s71, v6
    s_nop 1
    v_cndmask_b32 v6, 0, v4, vcc
    v_add_u32 v242, v6, v242
    s_branch nomask17
mask18:
    s_sub_u32 s71, 15, s65
    s_lshl_b32 s71, s71, 2
    v_mov_b32 v4, 0x40000000
    v_add_u32 v5, 0, v2
    v_mul_u32_u24 v6, s70, v5
    v_lshrrev_b32 v6, 19, v6
    v_mul_u32_u24 v6, 12, v6
    v_sub_u32 v6, v5, v6
    v_cmp_le_u32 vcc, s71, v6
    s_nop 1
    v_cndmask_b32 v6, 0, v4, vcc
    v_add_u32 v248, v6, v248
    v_add_u32 v5, 64, v2
    v_mul_u32_u24 v6, s70, v5
    v_lshrrev_b32 v6, 19, v6
    v_mul_u32_u24 v6, 12, v6
    v_sub_u32 v6, v5, v6
    v_cmp_le_u32 vcc, s71, v6
    s_nop 1
    v_cndmask_b32 v6, 0, v4, vcc
    v_add_u32 v249, v6, v249
    v_add_u32 v5, 128, v2
    v_mul_u32_u24 v6, s70, v5
    v_lshrrev_b32 v6, 19, v6
    v_mul_u32_u24 v6, 12, v6
    v_sub_u32 v6, v5, v6
    v_cmp_le_u32 vcc, s71, v6
    s_nop 1
    v_cndmask_b32 v6, 0, v4, vcc
    v_add_u32 v250, v6, v250
    s_branch nomask18
A_exit:
    s_endpgm
ka_end:
.section .rodata,"a"
.p2align 6
.amdhsa_kernel gated_mix__ssm_conv_s4d__glu_gated_geglu__prompt_kernel
  .amdhsa_next_free_vgpr 256
  .amdhsa_next_free_sgpr 102
  .amdhsa_accum_offset 256
  .amdhsa_group_segment_fixed_size 0
  .amdhsa_kernarg_size 120
  .amdhsa_user_sgpr_count 2
  .amdhsa_user_sgpr_kernarg_segment_ptr 1
  .amdhsa_system_sgpr_workgroup_id_x 1
.end_amdhsa_kernel
```
